```python
import torch

def _softmax(x, axis=-1):
    return torch.softmax(x, dim=axis)
def _gelu(x):
    return torch.nn.functional.gelu(x, approximate="tanh")
def _silu(x):
    return torch.nn.functional.silu(x)
def _sigmoid(x):
    return torch.sigmoid(x)
def _layernorm(x, axis=-1, eps=1e-5):
    m = x.mean(dim=axis, keepdim=True)
    v = x.var(dim=axis, keepdim=True, unbiased=False)
    return (x - m) / torch.sqrt(v + eps)
def _scatter_add(tgt, idx, src, axis=0):
    return tgt.clone().index_add_(axis, idx, src)
def _segment_sum(src, seg, n):
    out = torch.zeros((n,) + src.shape[1:], dtype=src.dtype)
    return out.index_add_(0, seg, src)
def _pad(x, pw):
    flat = tuple(v for pair in reversed(pw) for v in pair)
    return torch.nn.functional.pad(x, flat)

kernel_name = 'parallel_sum__ssm_conv_s4__dense_activation_gelu__prompt'

def setup_inputs():

    _w = (lambda a: (lambda t: t.to(torch.bfloat16) if t.is_floating_point() else t)(torch.as_tensor(a)))
    def _A_setup():
        B, L, D, N = 1, 2048, 640, 128
        A_re = -(lambda _x: torch.exp(torch.as_tensor(_x)))((lambda *s: torch.randn(*s, dtype=torch.bfloat16) * 6.4)(D, N))
        A_im = torch.pi * (lambda *s: torch.randn(*s, dtype=torch.bfloat16) * 0.05)(D, N)
        B_re = (lambda *s: torch.randn(*s, dtype=torch.bfloat16) * 0.1)(D, N)
        B_im = (lambda *s: torch.randn(*s, dtype=torch.bfloat16) * 0.1)(D, N)
        C_re = (lambda *s: torch.randn(*s, dtype=torch.bfloat16) * 0.1)(D, N)
        C_im = (lambda *s: torch.randn(*s, dtype=torch.bfloat16) * 0.1)(D, N)
        log_dt = (lambda *s: torch.randn(*s, dtype=torch.bfloat16) * 0.05)(D) * 0.5 - 4.0
        Dskip = (lambda *s: torch.randn(*s, dtype=torch.bfloat16) * 0.05)(D)
        return {
            "u": _w((lambda *s: torch.randn(*s, dtype=torch.bfloat16) * 0.05)(B, L, D)),
            "A_re": _w(A_re),
            "A_im": _w(A_im),
            "B_re": _w(B_re),
            "B_im": _w(B_im),
            "C_re": _w(C_re),
            "C_im": _w(C_im),
            "log_dt": _w(log_dt),
            "Dskip": _w(Dskip),
        }
    _A_in = _A_setup()

    def _B_setup():
        B, S, D, F = 1, 2048, 640, 1728
        return {
            "x": _w((lambda *s: torch.randn(*s, dtype=torch.bfloat16) * 0.05)(B, S, D)),
            "w1": _w((lambda *s: torch.randn(*s, dtype=torch.bfloat16) * 0.8)(D, F) * (D ** -0.5)),
            "b1": _w((lambda *s: torch.randn(*s, dtype=torch.bfloat16) * 0.2)(F) * 0.01),
            "w2": _w((lambda *s: torch.randn(*s, dtype=torch.bfloat16) * 0.2)(F, D) * (F ** -0.5)),
            "b2": _w((lambda *s: torch.randn(*s, dtype=torch.bfloat16) * 0.2)(D) * 0.01),
        }
    _B_in = _B_setup()

    return {
        "A_u": _A_in["u"],
        "A_A_re": _A_in["A_re"],
        "A_A_im": _A_in["A_im"],
        "A_B_re": _A_in["B_re"],
        "A_B_im": _A_in["B_im"],
        "A_C_re": _A_in["C_re"],
        "A_C_im": _A_in["C_im"],
        "A_log_dt": _A_in["log_dt"],
        "A_Dskip": _A_in["Dskip"],
        "B_x": _B_in["x"],
        "B_w1": _B_in["w1"],
        "B_b1": _B_in["b1"],
        "B_w2": _B_in["w2"],
        "B_b2": _B_in["b2"],
    }

def reference(A_u, A_A_re, A_A_im, A_B_re, A_B_im, A_C_re, A_C_im, A_log_dt, A_Dskip, B_x, B_w1, B_b1, B_w2, B_b2):
    def _A_ref(u, A_re, A_im, B_re, B_im, C_re, C_im, log_dt, Dskip):
        Bsz, L, D = u.shape
        dt = torch.exp(log_dt)[:, None]
        A = A_re + 1j * A_im
        Bc = B_re + 1j * B_im
        Cc = C_re + 1j * C_im
        logdA = dt * A
        dB = dt * Bc
        l = (lambda x, dt: x.to(dt))(torch.arange(L), A_re.dtype)
        P = torch.exp(logdA[:, :, None] * l[None, None, :])
        K = torch.einsum("dn,dnl,dn->dl", Cc, P, dB).real
        L2 = 2 * L
        Kp = _pad(K, ((0, 0), (0, L)))
        up = (lambda x, *d: x.permute(*d))(u, 0, 2, 1)
        up = _pad(up, ((0, 0), (0, 0), (0, L)))
        Kf = (lambda x, axes=(-2,-1): torch.fft.rfft2(x.float(), dim=axes))(Kp[:, None, :], axes=(-2, -1))
        Uf = (lambda x, axes=(-2,-1): torch.fft.rfft2(x.float(), dim=axes))(up[:, :, None, :], axes=(-2, -1))
        Yf = Uf * Kf[None, :, :, :]
        y = (lambda x, s, axes=(-2,-1): torch.fft.irfft2(x, s=s, dim=axes).to(torch.bfloat16))(Yf, (1, L2), axes=(-2, -1))[:, :, 0, :L]
        y = (lambda x, *d: x.permute(*d))(y, 0, 2, 1) + u * Dskip[None, None, :]
        return y

    def _B_ref(x, w1, b1, w2, b2):
        h = torch.einsum("bsd,df->bsf", x, w1) + b1
        h = _gelu(h)
        return torch.einsum("bsf,fd->bsd", h, w2) + b2

    x = A_u
    xn = _layernorm(x, axis=-1)
    return x + _A_ref(xn, A_A_re, A_A_im, A_B_re, A_B_im, A_C_re, A_C_im, A_log_dt, A_Dskip) + _B_ref(xn, B_w1, B_b1, B_w2, B_b2)
```

```asm
; @launch grid=(256,1,1) block=(512,1,1) lds=163840
.amdgcn_target "amdgcn-amd-amdhsa--gfx950"
.text
.globl parallel_sum__ssm_conv_s4__dense_activation_gelu__prompt_kernel
.p2align 8
.type parallel_sum__ssm_conv_s4__dense_activation_gelu__prompt_kernel,@function
parallel_sum__ssm_conv_s4__dense_activation_gelu__prompt_kernel:
    s_cmp_ge_u32 s2, 256
    s_cbranch_scc1 L_exit
    s_load_dwordx16 s[16:31], s[0:1], 0
    s_load_dwordx16 s[32:47], s[0:1], 64
    s_load_dwordx2 s[48:49], s[0:1], 128
    s_cmp_ge_u32 s2, 8
    s_cbranch_scc1 L_nocpf
    s_getpc_b64 s[12:13]
L_cpfb:
    v_lshlrev_b32 v20, 7, v0
    v_min_u32 v20, L_exit-L_cpfb, v20
    v_mov_b32 v21, s13
    v_add_co_u32 v20, vcc, s12, v20
    s_nop 1
    v_addc_co_u32 v21, vcc, 0, v21, vcc
    global_load_dword v22, v[20:21], off
L_nocpf:
    v_lshrrev_b32 v1, 6, v0
    v_and_b32 v0, 63, v0
    v_readfirstlane_b32 s4, v1
    s_bfe_u32 s5, s2, 0x20001
    s_and_b32 s6, s2, 1
    s_lshr_b32 s7, s2, 3
    s_mov_b32 s50, 0
    s_lshl_b32 s8, s6, 2
    s_sub_u32 s8, 20, s8
    s_cmp_eq_u32 s6, 0
    s_cselect_b32 s9, 52, 64
    s_mul_i32 s9, s9, s7
    s_lshr_b32 s9, s9, 8
    s_sub_u32 s11, 5, s6
    s_mul_i32 s11, s11, s9
    s_sub_u32 s10, s7, s11
    s_mul_i32 s11, s6, 5
    s_add_u32 s10, s10, s11
    s_lshl_b32 s11, s5, 2
    s_add_u32 s9, s9, s11
    v_lshrrev_b32 v4, 3, v0
    v_mul_u32_u24 v4, 1280, v4
    v_and_b32 v5, 7, v0
    v_lshrrev_b32 v6, 4, v0
    v_xor_b32 v5, v5, v6
    v_lshl_add_u32 v2, v5, 4, v4
    v_xor_b32 v5, 4, v5
    v_lshl_add_u32 v3, v5, 4, v4
    v_add_u32 v3, 10240, v3
    v_add_u32 v4, 20480, v2
    v_add_u32 v5, 20480, v3
    v_add_u32 v6, 0, v0
    v_mul_u32_u24 v7, 2731, v6
    v_lshrrev_b32 v7, 16, v7
    v_lshlrev_b32 v14, 1, v7
    v_and_b32 v14, 4, v14
    v_xor_b32 v6, v6, v14
    v_mul_u32_u24 v7, 3072, v7
    v_lshl_add_u32 v8, v6, 4, v7
    v_add_u32 v11, 27648, v8
    v_add_u32 v6, 64, v0
    v_mul_u32_u24 v7, 2731, v6
    v_lshrrev_b32 v7, 16, v7
    v_lshlrev_b32 v14, 1, v7
    v_and_b32 v14, 4, v14
    v_xor_b32 v6, v6, v14
    v_mul_u32_u24 v7, 3072, v7
    v_lshl_add_u32 v9, v6, 4, v7
    v_add_u32 v12, 27648, v9
    v_add_u32 v6, 128, v0
    v_mul_u32_u24 v7, 2731, v6
    v_lshrrev_b32 v7, 16, v7
    v_lshlrev_b32 v14, 1, v7
    v_and_b32 v14, 4, v14
    v_xor_b32 v6, v6, v14
    v_mul_u32_u24 v7, 3072, v7
    v_lshl_add_u32 v10, v6, 4, v7
    v_add_u32 v13, 27648, v10
    s_and_b32 s99, s4, 3
    s_lshl_b32 s11, s9, 7
    s_lshl_b32 s12, s99, 5
    s_add_u32 s11, s11, s12
    s_mul_i32 s11, s11, 1280
    s_mul_i32 s12, s99, 55296
    s_mul_i32 s13, s10, 384
    s_add_u32 s12, s12, s13
    s_lshl_b32 s13, s99, 12
    s_mul_i32 s14, s99, 6144
    s_add_u32 s14, s14, 16384
    s_mov_b32 s3, 0
    s_and_b32 s15, s9, 3
    s_mul_i32 s15, s15, 5
    s_add_u32 s15, s15, 1
    s_lshr_b32 s15, s15, 1
    s_lshl_b32 s68, s10, 1
    s_add_u32 s15, s15, s68
    s_add_u32 s15, s15, s5
    s_mul_i32 s68, s15, 26
    s_lshr_b32 s68, s68, 8
    s_mul_i32 s68, s68, 10
    s_sub_u32 s15, s15, s68
    s_lshl_b32 s68, s15, 7
    s_add_u32 s11, s11, s68
    s_mul_i32 s68, s15, 221184
    s_add_u32 s12, s12, s68
    s_mov_b32 s69, 0
    s_mov_b32 s54, 0x1100000
    s_mov_b32 s55, 0x20000
    s_mov_b32 s58, 0x280000
    s_mov_b32 s59, 0x20000
    s_mov_b32 s62, 0x21c000
    s_mov_b32 s63, 0x20000
    s_mov_b32 s66, 0x100
    s_mov_b32 s67, 0x20000
    v_mov_b32 v146, 0
    v_mov_b32 v253, 0
    s_mov_b32 s101, 0
    s_waitcnt lgkmcnt(0)
    s_mov_b64 s[56:57], s[16:17]
    s_mov_b64 s[60:61], s[36:37]
    s_mov_b64 s[52:53], s[48:49]
    s_mov_b64 s[64:65], s[46:47]
    s_lshl_b32 s34, s2, 7
    s_add_u32 s34, s34, 10158080
    s_cmp_ge_u32 s7, s8
    s_cbranch_scc1 L_aux
    s_cmp_lt_u32 s4, 4
    s_cbranch_scc1 L_comp
    s_mov_b32 s8, s99
L_ld_loop:
    s_cmp_lt_u32 s3, 2
    s_cbranch_scc1 L_ld_nowait
    s_cmp_eq_u32 s3, 2
    s_cbranch_scc1 L_ld_setup
L_ld_wait:
    s_waitcnt vmcnt(10)
    s_barrier
L_ld_nowait:
    s_add_u32 s70, s69, s13
    s_add_u32 s71, s69, s14
    s_add_u32 m0, s70, 0
    s_nop 0
    buffer_load_dwordx4 v2, s[56:59], s11 offen lds
    s_add_u32 m0, s70, 1024
    s_nop 0
    buffer_load_dwordx4 v3, s[56:59], s11 offen lds
    s_add_u32 m0, s70, 2048
    s_nop 0
    buffer_load_dwordx4 v4, s[56:59], s11 offen lds
    s_add_u32 m0, s70, 3072
    s_nop 0
    buffer_load_dwordx4 v5, s[56:59], s11 offen lds
    s_add_u32 m0, s71, 0
    s_nop 0
    buffer_load_dwordx4 v8, s[60:63], s12 offen lds
    s_add_u32 m0, s71, 1024
    s_nop 0
    buffer_load_dwordx4 v9, s[60:63], s12 offen lds
    s_add_u32 m0, s71, 2048
    s_nop 0
    buffer_load_dwordx4 v10, s[60:63], s12 offen lds
    s_add_u32 m0, s71, 3072
    s_nop 0
    buffer_load_dwordx4 v11, s[60:63], s12 offen lds
    s_add_u32 m0, s71, 4096
    s_nop 0
    buffer_load_dwordx4 v12, s[60:63], s12 offen lds
    s_add_u32 m0, s71, 5120
    s_nop 0
    buffer_load_dwordx4 v13, s[60:63], s12 offen lds
    s_add_u32 s11, s11, 128
    s_add_u32 s12, s12, 221184
    s_add_u32 s15, s15, 1
    s_cmp_lt_u32 s15, 10
    s_cbranch_scc1 L_ld_nowrap
    s_sub_u32 s11, s11, 1280
    s_sub_u32 s12, s12, 2211840
    s_mov_b32 s15, 0
L_ld_nowrap:
    s_add_u32 s69, s69, 40960
    s_cmp_eq_u32 s69, 122880
    s_cselect_b32 s69, 0, s69
    s_cmp_lg_u32 s3, 7
    s_cbranch_scc1 L_ld_n5
    s_load_dwordx4 s[28:31], s[46:47], 0
L_ld_n5:
    s_add_u32 s3, s3, 1
    s_cmp_lt_u32 s3, 10
    s_cbranch_scc1 L_ld_loop
    s_waitcnt lgkmcnt(0)
    s_and_b32 s28, s28, s29
    s_and_b32 s30, s30, s31
    s_and_b32 s24, s28, s30
    buffer_load_dwordx4 v[16:19], v1, s[52:55], s18 offen sc1
    buffer_load_dwordx4 v[20:23], v6, s[52:55], s18 offen offset:1024 sc1
    buffer_load_dword v24, v7, s[52:55], s20 offen sc1
    s_waitcnt vmcnt(13)
    s_barrier
    s_mov_b32 s31, 0
    s_mov_b32 s33, 0
    s_cmp_eq_u32 s101, 0
    s_cbranch_scc1 L_ld_ncv
    s_load_dword s31, s[48:49], s34 glc
    s_load_dword s33, s[48:49], s100 glc
L_ld_ncv:
    s_waitcnt vmcnt(3)
    s_barrier
    s_cmp_lg_u32 s24, 0
    s_cbranch_scc1 L_ld_clr
    s_mov_b64 exec, 15
    buffer_load_dword v15, v14, s[64:67], 0 offen sc1
    s_mov_b64 exec, -1
L_poll_1:
    s_waitcnt vmcnt(0)
    v_cmp_ne_u32 vcc, 0, v15
    s_nop 0
    s_and_b32 vcc_lo, vcc_lo, 15
    s_cmp_eq_u32 vcc_lo, 15
    s_cbranch_scc1 L_pdone_2
    s_add_u32 s50, s50, 1
    s_cmp_gt_u32 s50, 100000
    s_cbranch_scc1 L_exit
    s_sleep 8
    s_mov_b64 exec, 15
    buffer_load_dword v15, v14, s[64:67], 0 offen sc1
    s_mov_b64 exec, -1
    s_branch L_poll_1
L_pdone_2:
    buffer_load_dwordx4 v[16:19], v1, s[52:55], s18 offen sc1
    buffer_load_dwordx4 v[20:23], v6, s[52:55], s18 offen offset:1024 sc1
    buffer_load_dword v24, v7, s[52:55], s20 offen sc1
    s_waitcnt lgkmcnt(0)
    s_mov_b32 s31, 0
    s_mov_b32 s33, 0
L_ld_clr:
L_poll_3:
    s_waitcnt vmcnt(0)
    v_and_b32 v4, v17, v19
    v_and_b32 v5, v21, v23
    v_and_b32 v4, v4, v5
    v_and_b32 v4, 1, v4
    v_min_u32 v4, v4, v24
    v_cmp_ne_u32 vcc, 0, v4
    s_nop 0
    s_cmp_eq_u64 vcc, -1
    s_cbranch_scc1 L_pdone_4
    s_add_u32 s50, s50, 1
    s_cmp_gt_u32 s50, 100000
    s_cbranch_scc1 L_exit
    s_sleep 8
    buffer_load_dwordx4 v[16:19], v1, s[52:55], s18 offen sc1
    buffer_load_dwordx4 v[20:23], v6, s[52:55], s18 offen offset:1024 sc1
    buffer_load_dword v24, v7, s[52:55], s20 offen sc1
    s_branch L_poll_3
L_pdone_4:
    ds_write_b128 v25, v[16:19]
    ds_write_b128 v26, v[20:23] offset:1024
    ds_write_b32 v27, v24
    s_waitcnt lgkmcnt(0)
    s_mov_b32 s68, 0
    s_and_b32 s13, s31, s101
    s_cbranch_scc0 L_ld_nk0
    s_lshl_b32 s10, s51, 12
    s_add_u32 s10, s10, 2621440
    buffer_load_dwordx4 v[32:35], v1, s[52:55], s10 offen offset:0 sc1
    buffer_load_dwordx4 v[36:39], v1, s[52:55], s10 offen offset:1024 sc1
    buffer_load_dwordx4 v[40:43], v1, s[52:55], s10 offen offset:2048 sc1
    s_mov_b32 s68, 1
L_ld_nk0:
    s_cmp_ge_u32 s33, 64
    s_cbranch_scc0 L_ld_nk
    s_lshl_b32 s10, s51, 6
    buffer_load_dwordx4 v[148:151], v146, s[52:55], s10 offen sc1
    s_add_u32 s10, s10, 655360
    buffer_load_dwordx4 v[152:155], v146, s[52:55], s10 offen sc1
    s_add_u32 s10, s10, 655360
    buffer_load_dwordx4 v[156:159], v146, s[52:55], s10 offen sc1
    s_add_u32 s10, s10, 655360
    buffer_load_dwordx4 v[160:163], v146, s[52:55], s10 offen sc1
    s_add_u32 s10, s10, 655360
    s_or_b32 s68, s68, 2
L_ld_nk:
    s_barrier
    s_cmp_eq_u32 s4, 7
    s_cbranch_scc1 L_fetch
    s_cmp_eq_u32 s4, 6
    s_cbranch_scc1 L_park
    s_cmp_eq_u32 s101, 0
    s_cbranch_scc1 L_end
    s_mul_i32 s69, s4, 20480
    s_branch L_cv_upart
L_ld_setup:
    v_lshlrev_b32 v1, 4, v0
    v_and_b32 v7, 31, v0
    v_lshlrev_b32 v6, 4, v7
    v_lshlrev_b32 v7, 2, v7
    v_and_b32 v14, 3, v0
    v_lshlrev_b32 v14, 2, v14
    s_lshl_b32 s20, s9, 9
    s_lshl_b32 s23, s8, 7
    s_add_u32 s20, s20, s23
    s_add_u32 s20, s20, 10092544
    s_add_u32 s23, s23, 129024
    v_add_u32 v27, s23, v7
    s_mul_i32 s18, s10, 1536
    s_mul_i32 s19, s8, 13824
    s_add_u32 s18, s18, s19
    s_add_u32 s18, s18, 10100736
    s_mul_i32 s23, s8, 1536
    s_add_u32 s23, s23, 122880
    v_add_u32 v25, s23, v1
    v_add_u32 v26, s23, v6
    v_mov_b32 v30, 163456
    v_pk_mov_b32 v[32:33], 0, 0
    v_pk_mov_b32 v[34:35], 0, 0
    ds_write_b128 v30, v[32:35]
    s_and_b32 s25, s2, 31
    s_lshl_b32 s25, s25, 7
    s_add_u32 s25, s25, 10208256
    s_mul_i32 s23, s5, 36
    s_mul_i32 s22, s6, 20
    s_add_u32 s23, s23, s22
    s_add_u32 s23, s23, s7
    s_mul_i32 s22, s8, 144
    s_add_u32 s23, s23, s22
    s_cmp_ge_u32 s23, 192
    s_cbranch_scc1 L_ld_wait
    s_lshr_b32 s22, s23, 2
    s_lshl_b32 s22, s22, 3
    s_and_b32 s23, s23, 3
    s_add_u32 s51, s23, s22
    s_add_u32 s51, s51, 256
    s_lshl_b32 s101, 0x1000000, s8
    s_mov_b32 s96, s69
    s_mov_b32 s97, s10
    s_mov_b32 s98, s13
    s_mul_i32 s69, s4, 20480
    v_lshlrev_b32 v68, 4, v0
    v_add_u32 v247, s69, v68
    v_min_u32 v70, 5, v0
    v_lshl_add_u32 v248, v70, 4, s69
    v_lshlrev_b32 v68, 6, v70
    v_lshrrev_b32 v69, 1, v70
    v_lshl_add_u32 v68, v69, 4, v68
    v_add_u32 v255, s69, v68
    v_lshlrev_b32 v68, 6, v0
    v_lshrrev_b32 v69, 1, v0
    v_lshl_add_u32 v68, v69, 4, v68
    v_add_u32 v254, s69, v68
    v_lshrrev_b32 v68, 2, v0
    v_mul_u32_u24 v68, 40960, v68
    v_and_b32 v69, 3, v0
    v_lshl_add_u32 v146, v69, 4, v68
    v_and_b32 v64, 15, v0
    v_lshrrev_b32 v65, 4, v0
    v_and_b32 v66, 1, v65
    v_lshrrev_b32 v67, 1, v65
    v_sub_u32 v68, 15, v64
    v_and_b32 v69, 1, v68
    v_sub_u32 v68, v68, v69
    v_lshlrev_b32 v68, 1, v68
    v_lshl_add_u32 v70, v65, 1, v69
    v_mul_u32_u24 v70, 160, v70
    v_add_u32 v70, v70, v68
    s_add_u32 s10, s69, 1648
    v_add_u32 v249, s10, v70
    v_lshl_add_u32 v70, v66, 1, v69
    v_mul_u32_u24 v70, 160, v70
    v_add_u32 v70, v70, v68
    v_lshl_add_u32 v70, v67, 4, v70
    s_add_u32 s10, s69, 2928
    v_add_u32 v250, s10, v70
    v_mul_u32_u24 v68, 3104, v66
    v_lshlrev_b32 v69, 3, v65
    v_sub_u32 v68, v68, v69
    v_lshl_add_u32 v68, v64, 3, v68
    s_add_u32 s10, s69, 9656
    v_add_u32 v251, s10, v68
    v_mul_u32_u24 v68, 2064, v66
    v_lshl_add_u32 v68, v67, 8, v68
    v_lshl_add_u32 v68, v64, 3, v68
    s_add_u32 s10, s69, 15856
    v_add_u32 v252, s10, v68
    v_lshlrev_b32 v68, 2, v66
    v_lshrrev_b32 v70, 2, v64
    v_add_u32 v68, v68, v70
    v_mul_u32_u24 v68, 81920, v68
    v_lshl_add_u32 v68, v67, 6, v68
    v_and_b32 v70, 3, v64
    v_lshl_add_u32 v253, v70, 4, v68
    s_add_u32 s10, s69, 5504
    v_lshlrev_b32 v68, 5, v64
    v_lshl_add_u32 v68, v65, 4, v68
    v_add_u32 v237, s10, v68
    v_sub_u32 v70, v69, v64
    v_add_u32 v70, 15, v70
    v_sub_u32 v69, v64, v69
    v_lshrrev_b32 v68, 4, v70
    v_lshlrev_b32 v68, 4, v68
    v_lshl_add_u32 v68, v70, 3, v68
    v_add_u32 v231, s69, v68
    v_add_u32 v70, 4, v70
    v_lshrrev_b32 v68, 4, v70
    v_lshlrev_b32 v68, 4, v68
    v_lshl_add_u32 v68, v70, 3, v68
    v_add_u32 v236, s69, v68
    v_mov_b32 v64, 0xffff
    v_mov_b32 v65, 0xffff0000
    v_mov_b32 v66, -1
    v_cmp_eq_u32 vcc, -16, v69
    s_nop 1
    v_cndmask_b32 v204, 0, v64, vcc
    v_cmp_eq_u32 vcc, -15, v69
    s_nop 1
    v_cndmask_b32 v204, v204, v65, vcc
    v_cmp_eq_u32 vcc, -12, v69
    s_nop 1
    v_cndmask_b32 v224, 0, v66, vcc
    v_cmp_eq_u32 vcc, -13, v69
    s_nop 1
    v_cndmask_b32 v224, v224, v64, vcc
    v_cmp_eq_u32 vcc, -11, v69
    s_nop 1
    v_cndmask_b32 v224, v224, v65, vcc
    v_cmp_eq_u32 vcc, -14, v69
    s_nop 1
    v_cndmask_b32 v205, 0, v64, vcc
    v_cmp_eq_u32 vcc, -13, v69
    s_nop 1
    v_cndmask_b32 v205, v205, v65, vcc
    v_cmp_eq_u32 vcc, -10, v69
    s_nop 1
    v_cndmask_b32 v225, 0, v66, vcc
    v_cmp_eq_u32 vcc, -11, v69
    s_nop 1
    v_cndmask_b32 v225, v225, v64, vcc
    v_cmp_eq_u32 vcc, -9, v69
    s_nop 1
    v_cndmask_b32 v225, v225, v65, vcc
    v_cmp_eq_u32 vcc, -12, v69
    s_nop 1
    v_cndmask_b32 v206, 0, v64, vcc
    v_cmp_eq_u32 vcc, -11, v69
    s_nop 1
    v_cndmask_b32 v206, v206, v65, vcc
    v_cmp_eq_u32 vcc, -8, v69
    s_nop 1
    v_cndmask_b32 v226, 0, v66, vcc
    v_cmp_eq_u32 vcc, -9, v69
    s_nop 1
    v_cndmask_b32 v226, v226, v64, vcc
    v_cmp_eq_u32 vcc, -7, v69
    s_nop 1
    v_cndmask_b32 v226, v226, v65, vcc
    v_cmp_eq_u32 vcc, -10, v69
    s_nop 1
    v_cndmask_b32 v207, 0, v64, vcc
    v_cmp_eq_u32 vcc, -9, v69
    s_nop 1
    v_cndmask_b32 v207, v207, v65, vcc
    v_cmp_eq_u32 vcc, -6, v69
    s_nop 1
    v_cndmask_b32 v227, 0, v66, vcc
    v_cmp_eq_u32 vcc, -7, v69
    s_nop 1
    v_cndmask_b32 v227, v227, v64, vcc
    v_cmp_eq_u32 vcc, -5, v69
    s_nop 1
    v_cndmask_b32 v227, v227, v65, vcc
    s_mul_i32 s13, s51, 410
    s_lshr_b32 s13, s13, 16
    s_lshl_b32 s13, s13, 4
    s_and_b32 s100, s2, 15
    s_add_u32 s100, s100, s13
    s_lshl_b32 s100, s100, 7
    s_add_u32 s100, s100, 10190848
    s_lshl_b32 s22, s51, 1
    s_and_b32 s23, s22, 2
    s_sub_u32 s22, s22, s23
    s_load_dword s99, s[32:33], s22
    s_lshl_b32 s23, s23, 3
    s_waitcnt lgkmcnt(0)
    s_lshr_b32 s99, s99, s23
    s_and_b32 s99, s99, 0xffff
    v_mov_b32 v147, s99
    s_mov_b32 s69, s96
    s_mov_b32 s10, s97
    s_mov_b32 s13, s98
    s_branch L_ld_wait
L_comp:
    s_lshl_b32 s30, s5, 3
    s_lshr_b32 s31, s7, 2
    s_add_u32 s30, s30, s31
    s_lshl_b32 s31, s6, 2
    s_and_b32 s29, s7, 3
    s_add_u32 s31, s31, s29
    s_mul_i32 s28, s4, 7168
    s_max_u32 s28, s28, 1024
    s_sub_u32 s28, s28, 1024
    s_mul_i32 s27, s30, 221184
    s_add_u32 s27, s27, s28
    s_add_u32 s27, s27, 10485760
    s_add_u32 s29, s4, 0
    s_and_b32 s29, s29, 3
    s_mul_i32 s29, s29, 55296
    s_add_u32 s18, s27, s29
    s_add_u32 s29, s4, 1
    s_and_b32 s29, s29, 3
    s_mul_i32 s29, s29, 55296
    s_add_u32 s19, s27, s29
    s_add_u32 s29, s4, 2
    s_and_b32 s29, s29, 3
    s_mul_i32 s29, s29, 55296
    s_add_u32 s20, s27, s29
    s_add_u32 s29, s4, 3
    s_and_b32 s29, s29, 3
    s_mul_i32 s29, s29, 55296
    s_add_u32 s21, s27, s29
    s_mul_i32 s22, s31, 276480
    s_add_u32 s22, s22, s28
    s_add_u32 s22, s22, 7864320
    s_add_u32 s23, s22, 55296
    s_add_u32 s24, s22, 110592
    s_add_u32 s25, s22, 165888
    s_add_u32 s26, s22, 221184
    s_lshl_b32 s27, s30, 6
    s_lshl_b32 s29, s4, 4
    s_add_u32 s27, s27, s29
    s_mul_i32 s27, s27, 1280
    s_mul_i32 s29, s31, 160
    s_add_u32 s27, s27, s29
    s_mov_b32 s28, 0x1803
    s_cmp_eq_u32 s4, 1
    s_cselect_b32 s28, 0xe01c, s28
    s_cmp_eq_u32 s4, 2
    s_cselect_b32 s28, 0x38070, s28
    s_cmp_eq_u32 s4, 3
    s_cselect_b32 s28, 0xe01c0, s28
    v_lshlrev_b32 v252, 4, v0
    s_cmp_eq_u32 s4, 0
    s_cselect_b32 s30, 0x7f000000, 0
    v_add_u32 v253, s30, v252
    v_lshrrev_b32 v255, 4, v0
    v_lshlrev_b32 v255, 3, v255
    v_and_b32 v254, 15, v0
    v_mul_u32_u24 v254, 160, v254
    v_add_u32 v254, v254, v255
    s_mov_b32 s60, s42
    s_mov_b32 s61, s43
    s_mov_b32 s62, 0x500
    s_mov_b32 s63, 0x20000
    v_and_b32 v13, 31, v0
    v_lshrrev_b32 v14, 5, v0
    s_lshl_b32 s8, s4, 12
    v_lshlrev_b32 v15, 7, v13
    v_add_u32 v15, s8, v15
    v_bfe_u32 v7, v0, 1, 3
    v_xor_b32 v7, v7, v14
    v_xor_b32 v1, 0, v7
    v_lshl_add_u32 v2, v1, 4, v15
    v_xor_b32 v1, 2, v7
    v_lshl_add_u32 v3, v1, 4, v15
    v_xor_b32 v1, 4, v7
    v_lshl_add_u32 v4, v1, 4, v15
    v_xor_b32 v1, 6, v7
    v_lshl_add_u32 v5, v1, 4, v15
    v_bfe_u32 v1, v0, 2, 2
    v_lshl_add_u32 v1, v14, 3, v1
    v_mul_u32_u24 v1, 384, v1
    v_bfe_u32 v7, v0, 4, 1
    v_lshl_add_u32 v1, v7, 5, v1
    v_and_b32 v7, 3, v0
    v_lshl_add_u32 v1, v7, 3, v1
    v_add_u32 v1, 16384, v1
    v_bfe_u32 v7, v0, 3, 1
    v_lshlrev_b32 v7, 6, v7
    v_add_u32 v6, v1, v7
    v_sub_u32 v196, v1, v7
    v_mov_b32 v197, v196
    v_mov_b32 v8, v2
    v_mov_b32 v9, v3
    v_mov_b32 v10, v4
    v_mov_b32 v11, v5
    v_mov_b32 v12, v6
    v_pk_mov_b32 v[72:73], 0, 0
    v_pk_mov_b32 v[74:75], 0, 0
    v_pk_mov_b32 v[76:77], 0, 0
    v_pk_mov_b32 v[78:79], 0, 0
    v_pk_mov_b32 v[80:81], 0, 0
    v_pk_mov_b32 v[82:83], 0, 0
    v_pk_mov_b32 v[84:85], 0, 0
    v_pk_mov_b32 v[86:87], 0, 0
    v_pk_mov_b32 v[88:89], 0, 0
    v_pk_mov_b32 v[90:91], 0, 0
    v_pk_mov_b32 v[92:93], 0, 0
    v_pk_mov_b32 v[94:95], 0, 0
    v_pk_mov_b32 v[96:97], 0, 0
    v_pk_mov_b32 v[98:99], 0, 0
    v_pk_mov_b32 v[100:101], 0, 0
    v_pk_mov_b32 v[102:103], 0, 0
    v_pk_mov_b32 v[104:105], 0, 0
    v_pk_mov_b32 v[106:107], 0, 0
    v_pk_mov_b32 v[108:109], 0, 0
    v_pk_mov_b32 v[110:111], 0, 0
    v_pk_mov_b32 v[112:113], 0, 0
    v_pk_mov_b32 v[114:115], 0, 0
    v_pk_mov_b32 v[116:117], 0, 0
    v_pk_mov_b32 v[118:119], 0, 0
    v_pk_mov_b32 v[120:121], 0, 0
    v_pk_mov_b32 v[122:123], 0, 0
    v_pk_mov_b32 v[124:125], 0, 0
    v_pk_mov_b32 v[126:127], 0, 0
    v_pk_mov_b32 v[128:129], 0, 0
    v_pk_mov_b32 v[130:131], 0, 0
    v_pk_mov_b32 v[132:133], 0, 0
    v_pk_mov_b32 v[134:135], 0, 0
    v_pk_mov_b32 v[136:137], 0, 0
    v_pk_mov_b32 v[138:139], 0, 0
    v_pk_mov_b32 v[140:141], 0, 0
    v_pk_mov_b32 v[142:143], 0, 0
    v_pk_mov_b32 v[144:145], 0, 0
    v_pk_mov_b32 v[146:147], 0, 0
    v_pk_mov_b32 v[148:149], 0, 0
    v_pk_mov_b32 v[150:151], 0, 0
    v_pk_mov_b32 v[152:153], 0, 0
    v_pk_mov_b32 v[154:155], 0, 0
    v_pk_mov_b32 v[156:157], 0, 0
    v_pk_mov_b32 v[158:159], 0, 0
    v_pk_mov_b32 v[160:161], 0, 0
    v_pk_mov_b32 v[162:163], 0, 0
    v_pk_mov_b32 v[164:165], 0, 0
    v_pk_mov_b32 v[166:167], 0, 0
    s_lshl_b32 s11, s4, 7
    s_add_u32 s11, s11, 129024
    v_lshl_add_u32 v168, v13, 2, s11
    v_mul_u32_u24 v169, 3072, v14
    v_lshl_add_u32 v169, v13, 3, v169
    v_add_u32 v169, 122880, v169
    v_bfe_u32 v1, v0, 4, 1
    v_mul_u32_u24 v1, 55296, v1
    v_lshl_add_u32 v1, v14, 8, v1
    v_and_b32 v7, 15, v0
    v_lshl_add_u32 v1, v7, 4, v1
    s_lshl_b32 s8, s9, 3
    s_lshl_b32 s11, s4, 1
    s_add_u32 s8, s8, s11
    s_mul_i32 s8, s8, 54
    s_mul_i32 s11, s10, 3
    s_add_u32 s8, s8, s11
    s_lshl_b32 s8, s8, 10
    s_add_u32 s8, s8, 10485760
    s_lshl_b32 s12, s9, 1
    s_lshr_b32 s11, s4, 1
    s_add_u32 s12, s12, s11
    s_and_b32 s11, s12, 7
    s_lshl_b32 s11, s11, 5
    s_lshr_b32 s12, s12, 3
    s_lshl_b32 s12, s12, 1
    s_add_u32 s12, s12, s11
    s_lshl_b32 s12, s12, 7
    s_add_u32 s12, s12, 10158080
    s_and_b32 s11, s4, 1
    s_mul_i32 s11, s11, 11
    s_add_u32 s11, s11, s10
    s_lshl_b32 s11, 1, s11
    v_and_b32 v15, 3, v0
    v_lshlrev_b32 v15, 10, v15
    v_bfe_u32 v7, v0, 2, 1
    v_lshl_add_u32 v15, v7, 7, v15
    v_mov_b32 v14, s11
    s_and_b32 s69, s2, 31
    s_lshl_b32 s69, s69, 7
    s_add_u32 s69, s69, 10208256
    s_mov_b32 s15, 0
    s_mov_b32 s3, 0
    s_barrier
    ds_read_b128 v[16:19], v8
    ds_read_b64_tr_b16 v[20:21], v12 offset:0
    ds_read_b64_tr_b16 v[22:23], v12 offset:1536
    ds_read_b64_tr_b16 v[24:25], v197 offset:64
    ds_read_b64_tr_b16 v[26:27], v197 offset:1600
    ds_read_b64_tr_b16 v[28:29], v12 offset:128
    ds_read_b64_tr_b16 v[30:31], v12 offset:1664
    ds_read_b64_tr_b16 v[32:33], v197 offset:192
    ds_read_b64_tr_b16 v[34:35], v197 offset:1728
    ds_read_b64_tr_b16 v[36:37], v12 offset:256
    ds_read_b64_tr_b16 v[38:39], v12 offset:1792
    ds_read_b64_tr_b16 v[40:41], v197 offset:320
    ds_read_b64_tr_b16 v[42:43], v197 offset:1856
L_c_loop:
    s_waitcnt lgkmcnt(8)
    v_mfma_f32_32x32x16_bf16 v[72:87], v[20:23], v[16:19], v[72:87]
    ds_read_b128 v[44:47], v9
    ds_read_b64_tr_b16 v[48:49], v12 offset:6144
    ds_read_b64_tr_b16 v[50:51], v12 offset:7680
    v_mfma_f32_32x32x16_bf16 v[88:103], v[24:27], v[16:19], v[88:103]
    ds_read_b64_tr_b16 v[52:53], v197 offset:6208
    ds_read_b64_tr_b16 v[54:55], v197 offset:7744
    ds_read_b64_tr_b16 v[56:57], v12 offset:6272
    s_waitcnt lgkmcnt(10)
    v_mfma_f32_32x32x16_bf16 v[104:119], v[28:31], v[16:19], v[104:119]
    ds_read_b64_tr_b16 v[58:59], v12 offset:7808
    ds_read_b64_tr_b16 v[60:61], v197 offset:6336
    ds_read_b64_tr_b16 v[62:63], v197 offset:7872
    v_mfma_f32_32x32x16_bf16 v[120:135], v[32:35], v[16:19], v[120:135]
    ds_read_b64_tr_b16 v[64:65], v12 offset:6400
    ds_read_b64_tr_b16 v[66:67], v12 offset:7936
    s_waitcnt lgkmcnt(11)
    v_mfma_f32_32x32x16_bf16 v[136:151], v[36:39], v[16:19], v[136:151]
    ds_read_b64_tr_b16 v[68:69], v197 offset:6464
    ds_read_b64_tr_b16 v[70:71], v197 offset:8000
    v_mfma_f32_32x32x16_bf16 v[152:167], v[40:43], v[16:19], v[152:167]
    s_add_u32 s15, s15, 40960
    s_cmp_eq_u32 s15, 122880
    s_cselect_b32 s15, 0, s15
    v_add_u32 v8, s15, v2
    s_waitcnt lgkmcnt(8)
    v_mfma_f32_32x32x16_bf16 v[72:87], v[48:51], v[44:47], v[72:87]
    ds_read_b128 v[16:19], v10
    ds_read_b64_tr_b16 v[20:21], v12 offset:12288
    ds_read_b64_tr_b16 v[22:23], v12 offset:13824
    v_mfma_f32_32x32x16_bf16 v[88:103], v[52:55], v[44:47], v[88:103]
    ds_read_b64_tr_b16 v[24:25], v197 offset:12352
    ds_read_b64_tr_b16 v[26:27], v197 offset:13888
    ds_read_b64_tr_b16 v[28:29], v12 offset:12416
    s_waitcnt lgkmcnt(10)
    v_mfma_f32_32x32x16_bf16 v[104:119], v[56:59], v[44:47], v[104:119]
    ds_read_b64_tr_b16 v[30:31], v12 offset:13952
    ds_read_b64_tr_b16 v[32:33], v197 offset:12480
    ds_read_b64_tr_b16 v[34:35], v197 offset:14016
    v_mfma_f32_32x32x16_bf16 v[120:135], v[60:63], v[44:47], v[120:135]
    ds_read_b64_tr_b16 v[36:37], v12 offset:12544
    ds_read_b64_tr_b16 v[38:39], v12 offset:14080
    s_waitcnt lgkmcnt(11)
    v_mfma_f32_32x32x16_bf16 v[136:151], v[64:67], v[44:47], v[136:151]
    ds_read_b64_tr_b16 v[40:41], v197 offset:12608
    ds_read_b64_tr_b16 v[42:43], v197 offset:14144
    v_mfma_f32_32x32x16_bf16 v[152:167], v[68:71], v[44:47], v[152:167]
    v_add_u32 v9, s15, v3
    v_add_u32 v10, s15, v4
    s_waitcnt lgkmcnt(8)
    v_mfma_f32_32x32x16_bf16 v[72:87], v[20:23], v[16:19], v[72:87]
    ds_read_b128 v[44:47], v11
    ds_read_b64_tr_b16 v[48:49], v12 offset:18432
    ds_read_b64_tr_b16 v[50:51], v12 offset:19968
    v_mfma_f32_32x32x16_bf16 v[88:103], v[24:27], v[16:19], v[88:103]
    ds_read_b64_tr_b16 v[52:53], v197 offset:18496
    ds_read_b64_tr_b16 v[54:55], v197 offset:20032
    ds_read_b64_tr_b16 v[56:57], v12 offset:18560
    s_waitcnt lgkmcnt(10)
    v_mfma_f32_32x32x16_bf16 v[104:119], v[28:31], v[16:19], v[104:119]
    ds_read_b64_tr_b16 v[58:59], v12 offset:20096
    ds_read_b64_tr_b16 v[60:61], v197 offset:18624
    ds_read_b64_tr_b16 v[62:63], v197 offset:20160
    v_mfma_f32_32x32x16_bf16 v[120:135], v[32:35], v[16:19], v[120:135]
    ds_read_b64_tr_b16 v[64:65], v12 offset:18688
    ds_read_b64_tr_b16 v[66:67], v12 offset:20224
    s_waitcnt lgkmcnt(11)
    v_mfma_f32_32x32x16_bf16 v[136:151], v[36:39], v[16:19], v[136:151]
    ds_read_b64_tr_b16 v[68:69], v197 offset:18752
    ds_read_b64_tr_b16 v[70:71], v197 offset:20288
    v_mfma_f32_32x32x16_bf16 v[152:167], v[40:43], v[16:19], v[152:167]
    v_add_u32 v12, s15, v6
    v_add_u32 v197, s15, v196
    s_waitcnt lgkmcnt(0)
    s_barrier
    v_mfma_f32_32x32x16_bf16 v[72:87], v[48:51], v[44:47], v[72:87]
    ds_read_b128 v[16:19], v8
    ds_read_b64_tr_b16 v[20:21], v12 offset:0
    ds_read_b64_tr_b16 v[22:23], v12 offset:1536
    v_mfma_f32_32x32x16_bf16 v[88:103], v[52:55], v[44:47], v[88:103]
    ds_read_b64_tr_b16 v[24:25], v197 offset:64
    ds_read_b64_tr_b16 v[26:27], v197 offset:1600
    ds_read_b64_tr_b16 v[28:29], v12 offset:128
    v_mfma_f32_32x32x16_bf16 v[104:119], v[56:59], v[44:47], v[104:119]
    ds_read_b64_tr_b16 v[30:31], v12 offset:1664
    ds_read_b64_tr_b16 v[32:33], v197 offset:192
    ds_read_b64_tr_b16 v[34:35], v197 offset:1728
    v_mfma_f32_32x32x16_bf16 v[120:135], v[60:63], v[44:47], v[120:135]
    ds_read_b64_tr_b16 v[36:37], v12 offset:256
    ds_read_b64_tr_b16 v[38:39], v12 offset:1792
    v_mfma_f32_32x32x16_bf16 v[136:151], v[64:67], v[44:47], v[136:151]
    ds_read_b64_tr_b16 v[40:41], v197 offset:320
    ds_read_b64_tr_b16 v[42:43], v197 offset:1856
    v_mfma_f32_32x32x16_bf16 v[152:167], v[68:71], v[44:47], v[152:167]
    v_add_u32 v11, s15, v5
    s_add_u32 s3, s3, 1
    s_cmp_lt_u32 s3, 10
    s_cbranch_scc1 L_c_loop
    s_setprio 3
    ds_read_b32 v170, v168
    ds_read_b64 v[172:173], v169 offset:0
    ds_read_b64 v[174:175], v169 offset:1536
    ds_read_b64 v[176:177], v169 offset:256
    ds_read_b64 v[178:179], v169 offset:1792
    ds_read_b64 v[180:181], v169 offset:512
    ds_read_b64 v[182:183], v169 offset:2048
    ds_read_b64 v[184:185], v169 offset:768
    ds_read_b64 v[186:187], v169 offset:2304
    ds_read_b64 v[188:189], v169 offset:1024
    ds_read_b64 v[190:191], v169 offset:2560
    ds_read_b64 v[192:193], v169 offset:1280
    ds_read_b64 v[194:195], v169 offset:2816
    s_waitcnt lgkmcnt(12)
    v_xor_b32 v17, 0x8000, v170
    v_and_b32 v19, 0xffff, v17
    v_lshl_or_b32 v16, v19, 16, v19
    v_mov_b32 v18, v16
    v_cmp_gt_u32 vcc, 32, v0
    s_nop 1
    v_cndmask_b32 v17, v19, v17, vcc
    v_and_b32 v10, 0xffff0000, v170
    v_rcp_f32 v7, v10
    v_mov_b32 v11, v10
    s_waitcnt lgkmcnt(0)
    v_mfma_f32_32x32x16_bf16 v[72:87], v[172:175], v[16:19], v[72:87]
    v_mul_f32 v8, 0xc0135761, v7
    v_mul_f32 v12, v7, v7
    v_mul_f32 v12, v12, v7
    v_mul_f32 v12, 0xbdd2d3e8, v12
    v_mov_b32 v9, v8
    v_mov_b32 v13, v12
    v_mfma_f32_32x32x16_bf16 v[88:103], v[176:179], v[16:19], v[88:103]
    v_mfma_f32_32x32x16_bf16 v[104:119], v[180:183], v[16:19], v[104:119]
    v_mfma_f32_32x32x16_bf16 v[120:135], v[184:187], v[16:19], v[120:135]
    v_mfma_f32_32x32x16_bf16 v[136:151], v[188:191], v[16:19], v[136:151]
    v_mfma_f32_32x32x16_bf16 v[152:167], v[192:195], v[16:19], v[152:167]
    s_nop 0
    v_pk_mul_f32 v[16:17], v[72:73], v[72:73]
    v_pk_mul_f32 v[18:19], v[74:75], v[74:75]
    v_pk_mul_f32 v[20:21], v[76:77], v[76:77]
    v_pk_mul_f32 v[22:23], v[78:79], v[78:79]
    v_pk_fma_f32 v[16:17], v[16:17], v[12:13], v[8:9]
    v_pk_fma_f32 v[18:19], v[18:19], v[12:13], v[8:9]
    v_pk_fma_f32 v[20:21], v[20:21], v[12:13], v[8:9]
    v_pk_fma_f32 v[22:23], v[22:23], v[12:13], v[8:9]
    v_pk_mul_f32 v[16:17], v[16:17], v[72:73]
    v_pk_mul_f32 v[18:19], v[18:19], v[74:75]
    v_pk_mul_f32 v[20:21], v[20:21], v[76:77]
    v_pk_mul_f32 v[22:23], v[22:23], v[78:79]
    v_exp_f32 v16, v16
    v_exp_f32 v17, v17
    v_exp_f32 v18, v18
    v_exp_f32 v19, v19
    v_exp_f32 v20, v20
    v_exp_f32 v21, v21
    v_exp_f32 v22, v22
    v_exp_f32 v23, v23
    v_pk_fma_f32 v[16:17], v[16:17], v[10:11], v[10:11]
    v_pk_fma_f32 v[18:19], v[18:19], v[10:11], v[10:11]
    v_pk_fma_f32 v[20:21], v[20:21], v[10:11], v[10:11]
    v_pk_fma_f32 v[22:23], v[22:23], v[10:11], v[10:11]
    v_rcp_f32 v16, v16
    v_pk_mul_f32 v[24:25], v[80:81], v[80:81]
    v_rcp_f32 v17, v17
    v_pk_mul_f32 v[26:27], v[82:83], v[82:83]
    v_pk_mul_f32 v[28:29], v[84:85], v[84:85]
    v_rcp_f32 v18, v18
    v_pk_mul_f32 v[30:31], v[86:87], v[86:87]
    v_rcp_f32 v19, v19
    v_pk_fma_f32 v[24:25], v[24:25], v[12:13], v[8:9]
    v_pk_fma_f32 v[26:27], v[26:27], v[12:13], v[8:9]
    v_rcp_f32 v20, v20
    v_pk_fma_f32 v[28:29], v[28:29], v[12:13], v[8:9]
    v_rcp_f32 v21, v21
    v_pk_fma_f32 v[30:31], v[30:31], v[12:13], v[8:9]
    v_pk_mul_f32 v[24:25], v[24:25], v[80:81]
    v_rcp_f32 v22, v22
    v_pk_mul_f32 v[26:27], v[26:27], v[82:83]
    v_rcp_f32 v23, v23
    v_pk_mul_f32 v[28:29], v[28:29], v[84:85]
    v_pk_mul_f32 v[30:31], v[30:31], v[86:87]
    v_exp_f32 v24, v24
    v_pk_mul_f32 v[16:17], v[16:17], v[72:73]
    v_exp_f32 v25, v25
    v_pk_mul_f32 v[18:19], v[18:19], v[74:75]
    v_exp_f32 v26, v26
    v_pk_mul_f32 v[20:21], v[20:21], v[76:77]
    v_exp_f32 v27, v27
    v_pk_mul_f32 v[22:23], v[22:23], v[78:79]
    v_exp_f32 v28, v28
    v_cvt_pk_bf16_f32 v48, v16, v17
    v_exp_f32 v29, v29
    v_cvt_pk_bf16_f32 v49, v18, v19
    v_exp_f32 v30, v30
    v_cvt_pk_bf16_f32 v50, v20, v21
    v_exp_f32 v31, v31
    v_cvt_pk_bf16_f32 v51, v22, v23
    buffer_store_dwordx4 v[48:51], v1, s[52:55], s8 offen offset:0 sc1
    v_pk_fma_f32 v[24:25], v[24:25], v[10:11], v[10:11]
    v_pk_fma_f32 v[26:27], v[26:27], v[10:11], v[10:11]
    v_pk_fma_f32 v[28:29], v[28:29], v[10:11], v[10:11]
    v_pk_fma_f32 v[30:31], v[30:31], v[10:11], v[10:11]
    v_rcp_f32 v24, v24
    v_pk_mul_f32 v[32:33], v[88:89], v[88:89]
    v_rcp_f32 v25, v25
    v_pk_mul_f32 v[34:35], v[90:91], v[90:91]
    v_pk_mul_f32 v[36:37], v[92:93], v[92:93]
    v_rcp_f32 v26, v26
    v_pk_mul_f32 v[38:39], v[94:95], v[94:95]
    v_rcp_f32 v27, v27
    v_pk_fma_f32 v[32:33], v[32:33], v[12:13], v[8:9]
    v_pk_fma_f32 v[34:35], v[34:35], v[12:13], v[8:9]
    v_rcp_f32 v28, v28
    v_pk_fma_f32 v[36:37], v[36:37], v[12:13], v[8:9]
    v_rcp_f32 v29, v29
    v_pk_fma_f32 v[38:39], v[38:39], v[12:13], v[8:9]
    v_pk_mul_f32 v[32:33], v[32:33], v[88:89]
    v_rcp_f32 v30, v30
    v_pk_mul_f32 v[34:35], v[34:35], v[90:91]
    v_rcp_f32 v31, v31
    v_pk_mul_f32 v[36:37], v[36:37], v[92:93]
    v_pk_mul_f32 v[38:39], v[38:39], v[94:95]
    v_exp_f32 v32, v32
    v_pk_mul_f32 v[24:25], v[24:25], v[80:81]
    v_exp_f32 v33, v33
    v_pk_mul_f32 v[26:27], v[26:27], v[82:83]
    v_exp_f32 v34, v34
    v_pk_mul_f32 v[28:29], v[28:29], v[84:85]
    v_exp_f32 v35, v35
    v_pk_mul_f32 v[30:31], v[30:31], v[86:87]
    v_exp_f32 v36, v36
    v_cvt_pk_bf16_f32 v52, v24, v25
    v_exp_f32 v37, v37
    v_cvt_pk_bf16_f32 v53, v26, v27
    v_exp_f32 v38, v38
    v_cvt_pk_bf16_f32 v54, v28, v29
    v_exp_f32 v39, v39
    v_cvt_pk_bf16_f32 v55, v30, v31
    buffer_store_dwordx4 v[52:55], v1, s[52:55], s8 offen offset:512 sc1
    v_pk_fma_f32 v[32:33], v[32:33], v[10:11], v[10:11]
    v_pk_fma_f32 v[34:35], v[34:35], v[10:11], v[10:11]
    v_pk_fma_f32 v[36:37], v[36:37], v[10:11], v[10:11]
    v_pk_fma_f32 v[38:39], v[38:39], v[10:11], v[10:11]
    v_rcp_f32 v32, v32
    v_pk_mul_f32 v[16:17], v[96:97], v[96:97]
    v_rcp_f32 v33, v33
    v_pk_mul_f32 v[18:19], v[98:99], v[98:99]
    v_pk_mul_f32 v[20:21], v[100:101], v[100:101]
    v_rcp_f32 v34, v34
    v_pk_mul_f32 v[22:23], v[102:103], v[102:103]
    v_rcp_f32 v35, v35
    v_pk_fma_f32 v[16:17], v[16:17], v[12:13], v[8:9]
    v_pk_fma_f32 v[18:19], v[18:19], v[12:13], v[8:9]
    v_rcp_f32 v36, v36
    v_pk_fma_f32 v[20:21], v[20:21], v[12:13], v[8:9]
    v_rcp_f32 v37, v37
    v_pk_fma_f32 v[22:23], v[22:23], v[12:13], v[8:9]
    v_pk_mul_f32 v[16:17], v[16:17], v[96:97]
    v_rcp_f32 v38, v38
    v_pk_mul_f32 v[18:19], v[18:19], v[98:99]
    v_rcp_f32 v39, v39
    v_pk_mul_f32 v[20:21], v[20:21], v[100:101]
    v_pk_mul_f32 v[22:23], v[22:23], v[102:103]
    v_exp_f32 v16, v16
    v_pk_mul_f32 v[32:33], v[32:33], v[88:89]
    v_exp_f32 v17, v17
    v_pk_mul_f32 v[34:35], v[34:35], v[90:91]
    v_exp_f32 v18, v18
    v_pk_mul_f32 v[36:37], v[36:37], v[92:93]
    v_exp_f32 v19, v19
    v_pk_mul_f32 v[38:39], v[38:39], v[94:95]
    v_exp_f32 v20, v20
    v_cvt_pk_bf16_f32 v56, v32, v33
    v_exp_f32 v21, v21
    v_cvt_pk_bf16_f32 v57, v34, v35
    v_exp_f32 v22, v22
    v_cvt_pk_bf16_f32 v58, v36, v37
    v_exp_f32 v23, v23
    v_cvt_pk_bf16_f32 v59, v38, v39
    buffer_store_dwordx4 v[56:59], v1, s[52:55], s8 offen offset:1024 sc1
    v_pk_fma_f32 v[16:17], v[16:17], v[10:11], v[10:11]
    v_pk_fma_f32 v[18:19], v[18:19], v[10:11], v[10:11]
    v_pk_fma_f32 v[20:21], v[20:21], v[10:11], v[10:11]
    v_pk_fma_f32 v[22:23], v[22:23], v[10:11], v[10:11]
    v_rcp_f32 v16, v16
    v_pk_mul_f32 v[24:25], v[104:105], v[104:105]
    v_rcp_f32 v17, v17
    v_pk_mul_f32 v[26:27], v[106:107], v[106:107]
    v_pk_mul_f32 v[28:29], v[108:109], v[108:109]
    v_rcp_f32 v18, v18
    v_pk_mul_f32 v[30:31], v[110:111], v[110:111]
    v_rcp_f32 v19, v19
    v_pk_fma_f32 v[24:25], v[24:25], v[12:13], v[8:9]
    v_pk_fma_f32 v[26:27], v[26:27], v[12:13], v[8:9]
    v_rcp_f32 v20, v20
    v_pk_fma_f32 v[28:29], v[28:29], v[12:13], v[8:9]
    v_rcp_f32 v21, v21
    v_pk_fma_f32 v[30:31], v[30:31], v[12:13], v[8:9]
    v_pk_mul_f32 v[24:25], v[24:25], v[104:105]
    v_rcp_f32 v22, v22
    v_pk_mul_f32 v[26:27], v[26:27], v[106:107]
    v_rcp_f32 v23, v23
    v_pk_mul_f32 v[28:29], v[28:29], v[108:109]
    v_pk_mul_f32 v[30:31], v[30:31], v[110:111]
    v_exp_f32 v24, v24
    v_pk_mul_f32 v[16:17], v[16:17], v[96:97]
    v_exp_f32 v25, v25
    v_pk_mul_f32 v[18:19], v[18:19], v[98:99]
    v_exp_f32 v26, v26
    v_pk_mul_f32 v[20:21], v[20:21], v[100:101]
    v_exp_f32 v27, v27
    v_pk_mul_f32 v[22:23], v[22:23], v[102:103]
    v_exp_f32 v28, v28
    v_cvt_pk_bf16_f32 v60, v16, v17
    v_exp_f32 v29, v29
    v_cvt_pk_bf16_f32 v61, v18, v19
    v_exp_f32 v30, v30
    v_cvt_pk_bf16_f32 v62, v20, v21
    v_exp_f32 v31, v31
    v_cvt_pk_bf16_f32 v63, v22, v23
    buffer_store_dwordx4 v[60:63], v1, s[52:55], s8 offen offset:1536 sc1
    v_pk_fma_f32 v[24:25], v[24:25], v[10:11], v[10:11]
    v_pk_fma_f32 v[26:27], v[26:27], v[10:11], v[10:11]
    v_pk_fma_f32 v[28:29], v[28:29], v[10:11], v[10:11]
    v_pk_fma_f32 v[30:31], v[30:31], v[10:11], v[10:11]
    v_rcp_f32 v24, v24
    v_pk_mul_f32 v[32:33], v[112:113], v[112:113]
    v_rcp_f32 v25, v25
    v_pk_mul_f32 v[34:35], v[114:115], v[114:115]
    v_pk_mul_f32 v[36:37], v[116:117], v[116:117]
    v_rcp_f32 v26, v26
    v_pk_mul_f32 v[38:39], v[118:119], v[118:119]
    v_rcp_f32 v27, v27
    v_pk_fma_f32 v[32:33], v[32:33], v[12:13], v[8:9]
    v_pk_fma_f32 v[34:35], v[34:35], v[12:13], v[8:9]
    v_rcp_f32 v28, v28
    v_pk_fma_f32 v[36:37], v[36:37], v[12:13], v[8:9]
    v_rcp_f32 v29, v29
    v_pk_fma_f32 v[38:39], v[38:39], v[12:13], v[8:9]
    v_pk_mul_f32 v[32:33], v[32:33], v[112:113]
    v_rcp_f32 v30, v30
    v_pk_mul_f32 v[34:35], v[34:35], v[114:115]
    v_rcp_f32 v31, v31
    v_pk_mul_f32 v[36:37], v[36:37], v[116:117]
    v_pk_mul_f32 v[38:39], v[38:39], v[118:119]
    v_exp_f32 v32, v32
    v_pk_mul_f32 v[24:25], v[24:25], v[104:105]
    v_exp_f32 v33, v33
    v_pk_mul_f32 v[26:27], v[26:27], v[106:107]
    v_exp_f32 v34, v34
    v_pk_mul_f32 v[28:29], v[28:29], v[108:109]
    v_exp_f32 v35, v35
    v_pk_mul_f32 v[30:31], v[30:31], v[110:111]
    v_exp_f32 v36, v36
    v_cvt_pk_bf16_f32 v48, v24, v25
    v_exp_f32 v37, v37
    v_cvt_pk_bf16_f32 v49, v26, v27
    v_exp_f32 v38, v38
    v_cvt_pk_bf16_f32 v50, v28, v29
    v_exp_f32 v39, v39
    v_cvt_pk_bf16_f32 v51, v30, v31
    buffer_store_dwordx4 v[48:51], v1, s[52:55], s8 offen offset:2048 sc1
    v_pk_fma_f32 v[32:33], v[32:33], v[10:11], v[10:11]
    v_pk_fma_f32 v[34:35], v[34:35], v[10:11], v[10:11]
    v_pk_fma_f32 v[36:37], v[36:37], v[10:11], v[10:11]
    v_pk_fma_f32 v[38:39], v[38:39], v[10:11], v[10:11]
    v_rcp_f32 v32, v32
    v_pk_mul_f32 v[16:17], v[120:121], v[120:121]
    v_rcp_f32 v33, v33
    v_pk_mul_f32 v[18:19], v[122:123], v[122:123]
    v_pk_mul_f32 v[20:21], v[124:125], v[124:125]
    v_rcp_f32 v34, v34
    v_pk_mul_f32 v[22:23], v[126:127], v[126:127]
    v_rcp_f32 v35, v35
    v_pk_fma_f32 v[16:17], v[16:17], v[12:13], v[8:9]
    v_pk_fma_f32 v[18:19], v[18:19], v[12:13], v[8:9]
    v_rcp_f32 v36, v36
    v_pk_fma_f32 v[20:21], v[20:21], v[12:13], v[8:9]
    v_rcp_f32 v37, v37
    v_pk_fma_f32 v[22:23], v[22:23], v[12:13], v[8:9]
    v_pk_mul_f32 v[16:17], v[16:17], v[120:121]
    v_rcp_f32 v38, v38
    v_pk_mul_f32 v[18:19], v[18:19], v[122:123]
    v_rcp_f32 v39, v39
    v_pk_mul_f32 v[20:21], v[20:21], v[124:125]
    v_pk_mul_f32 v[22:23], v[22:23], v[126:127]
    v_exp_f32 v16, v16
    v_pk_mul_f32 v[32:33], v[32:33], v[112:113]
    v_exp_f32 v17, v17
    v_pk_mul_f32 v[34:35], v[34:35], v[114:115]
    v_exp_f32 v18, v18
    v_pk_mul_f32 v[36:37], v[36:37], v[116:117]
    v_exp_f32 v19, v19
    v_pk_mul_f32 v[38:39], v[38:39], v[118:119]
    v_exp_f32 v20, v20
    v_cvt_pk_bf16_f32 v52, v32, v33
    v_exp_f32 v21, v21
    v_cvt_pk_bf16_f32 v53, v34, v35
    v_exp_f32 v22, v22
    v_cvt_pk_bf16_f32 v54, v36, v37
    v_exp_f32 v23, v23
    v_cvt_pk_bf16_f32 v55, v38, v39
    buffer_store_dwordx4 v[52:55], v1, s[52:55], s8 offen offset:2560 sc1
    s_add_u32 s8, s8, 27648
    v_pk_fma_f32 v[16:17], v[16:17], v[10:11], v[10:11]
    v_pk_fma_f32 v[18:19], v[18:19], v[10:11], v[10:11]
    v_pk_fma_f32 v[20:21], v[20:21], v[10:11], v[10:11]
    v_pk_fma_f32 v[22:23], v[22:23], v[10:11], v[10:11]
    v_rcp_f32 v16, v16
    v_pk_mul_f32 v[24:25], v[128:129], v[128:129]
    v_rcp_f32 v17, v17
    v_pk_mul_f32 v[26:27], v[130:131], v[130:131]
    v_pk_mul_f32 v[28:29], v[132:133], v[132:133]
    v_rcp_f32 v18, v18
    v_pk_mul_f32 v[30:31], v[134:135], v[134:135]
    v_rcp_f32 v19, v19
    v_pk_fma_f32 v[24:25], v[24:25], v[12:13], v[8:9]
    v_pk_fma_f32 v[26:27], v[26:27], v[12:13], v[8:9]
    v_rcp_f32 v20, v20
    v_pk_fma_f32 v[28:29], v[28:29], v[12:13], v[8:9]
    v_rcp_f32 v21, v21
    v_pk_fma_f32 v[30:31], v[30:31], v[12:13], v[8:9]
    v_pk_mul_f32 v[24:25], v[24:25], v[128:129]
    v_rcp_f32 v22, v22
    v_pk_mul_f32 v[26:27], v[26:27], v[130:131]
    v_rcp_f32 v23, v23
    v_pk_mul_f32 v[28:29], v[28:29], v[132:133]
    v_pk_mul_f32 v[30:31], v[30:31], v[134:135]
    v_exp_f32 v24, v24
    v_pk_mul_f32 v[16:17], v[16:17], v[120:121]
    v_exp_f32 v25, v25
    v_pk_mul_f32 v[18:19], v[18:19], v[122:123]
    v_exp_f32 v26, v26
    v_pk_mul_f32 v[20:21], v[20:21], v[124:125]
    v_exp_f32 v27, v27
    v_pk_mul_f32 v[22:23], v[22:23], v[126:127]
    v_exp_f32 v28, v28
    v_cvt_pk_bf16_f32 v56, v16, v17
    v_exp_f32 v29, v29
    v_cvt_pk_bf16_f32 v57, v18, v19
    v_exp_f32 v30, v30
    v_cvt_pk_bf16_f32 v58, v20, v21
    v_exp_f32 v31, v31
    v_cvt_pk_bf16_f32 v59, v22, v23
    buffer_store_dwordx4 v[56:59], v1, s[52:55], s8 offen offset:0 sc1
    v_pk_fma_f32 v[24:25], v[24:25], v[10:11], v[10:11]
    v_pk_fma_f32 v[26:27], v[26:27], v[10:11], v[10:11]
    v_pk_fma_f32 v[28:29], v[28:29], v[10:11], v[10:11]
    v_pk_fma_f32 v[30:31], v[30:31], v[10:11], v[10:11]
    v_rcp_f32 v24, v24
    v_pk_mul_f32 v[32:33], v[136:137], v[136:137]
    v_rcp_f32 v25, v25
    v_pk_mul_f32 v[34:35], v[138:139], v[138:139]
    v_pk_mul_f32 v[36:37], v[140:141], v[140:141]
    v_rcp_f32 v26, v26
    v_pk_mul_f32 v[38:39], v[142:143], v[142:143]
    v_rcp_f32 v27, v27
    v_pk_fma_f32 v[32:33], v[32:33], v[12:13], v[8:9]
    v_pk_fma_f32 v[34:35], v[34:35], v[12:13], v[8:9]
    v_rcp_f32 v28, v28
    v_pk_fma_f32 v[36:37], v[36:37], v[12:13], v[8:9]
    v_rcp_f32 v29, v29
    v_pk_fma_f32 v[38:39], v[38:39], v[12:13], v[8:9]
    v_pk_mul_f32 v[32:33], v[32:33], v[136:137]
    v_rcp_f32 v30, v30
    v_pk_mul_f32 v[34:35], v[34:35], v[138:139]
    v_rcp_f32 v31, v31
    v_pk_mul_f32 v[36:37], v[36:37], v[140:141]
    v_pk_mul_f32 v[38:39], v[38:39], v[142:143]
    v_exp_f32 v32, v32
    v_pk_mul_f32 v[24:25], v[24:25], v[128:129]
    v_exp_f32 v33, v33
    v_pk_mul_f32 v[26:27], v[26:27], v[130:131]
    v_exp_f32 v34, v34
    v_pk_mul_f32 v[28:29], v[28:29], v[132:133]
    v_exp_f32 v35, v35
    v_pk_mul_f32 v[30:31], v[30:31], v[134:135]
    v_exp_f32 v36, v36
    v_cvt_pk_bf16_f32 v60, v24, v25
    v_exp_f32 v37, v37
    v_cvt_pk_bf16_f32 v61, v26, v27
    v_exp_f32 v38, v38
    v_cvt_pk_bf16_f32 v62, v28, v29
    v_exp_f32 v39, v39
    v_cvt_pk_bf16_f32 v63, v30, v31
    buffer_store_dwordx4 v[60:63], v1, s[52:55], s8 offen offset:512 sc1
    v_pk_fma_f32 v[32:33], v[32:33], v[10:11], v[10:11]
    v_pk_fma_f32 v[34:35], v[34:35], v[10:11], v[10:11]
    v_pk_fma_f32 v[36:37], v[36:37], v[10:11], v[10:11]
    v_pk_fma_f32 v[38:39], v[38:39], v[10:11], v[10:11]
    v_rcp_f32 v32, v32
    v_pk_mul_f32 v[16:17], v[144:145], v[144:145]
    v_rcp_f32 v33, v33
    v_pk_mul_f32 v[18:19], v[146:147], v[146:147]
    v_pk_mul_f32 v[20:21], v[148:149], v[148:149]
    v_rcp_f32 v34, v34
    v_pk_mul_f32 v[22:23], v[150:151], v[150:151]
    v_rcp_f32 v35, v35
    v_pk_fma_f32 v[16:17], v[16:17], v[12:13], v[8:9]
    v_pk_fma_f32 v[18:19], v[18:19], v[12:13], v[8:9]
    v_rcp_f32 v36, v36
    v_pk_fma_f32 v[20:21], v[20:21], v[12:13], v[8:9]
    v_rcp_f32 v37, v37
    v_pk_fma_f32 v[22:23], v[22:23], v[12:13], v[8:9]
    v_pk_mul_f32 v[16:17], v[16:17], v[144:145]
    v_rcp_f32 v38, v38
    v_pk_mul_f32 v[18:19], v[18:19], v[146:147]
    v_rcp_f32 v39, v39
    v_pk_mul_f32 v[20:21], v[20:21], v[148:149]
    v_pk_mul_f32 v[22:23], v[22:23], v[150:151]
    v_exp_f32 v16, v16
    v_pk_mul_f32 v[32:33], v[32:33], v[136:137]
    v_exp_f32 v17, v17
    v_pk_mul_f32 v[34:35], v[34:35], v[138:139]
    v_exp_f32 v18, v18
    v_pk_mul_f32 v[36:37], v[36:37], v[140:141]
    v_exp_f32 v19, v19
    v_pk_mul_f32 v[38:39], v[38:39], v[142:143]
    v_exp_f32 v20, v20
    v_cvt_pk_bf16_f32 v48, v32, v33
    v_exp_f32 v21, v21
    v_cvt_pk_bf16_f32 v49, v34, v35
    v_exp_f32 v22, v22
    v_cvt_pk_bf16_f32 v50, v36, v37
    v_exp_f32 v23, v23
    v_cvt_pk_bf16_f32 v51, v38, v39
    buffer_store_dwordx4 v[48:51], v1, s[52:55], s8 offen offset:1024 sc1
    v_pk_fma_f32 v[16:17], v[16:17], v[10:11], v[10:11]
    v_pk_fma_f32 v[18:19], v[18:19], v[10:11], v[10:11]
    v_pk_fma_f32 v[20:21], v[20:21], v[10:11], v[10:11]
    v_pk_fma_f32 v[22:23], v[22:23], v[10:11], v[10:11]
    v_rcp_f32 v16, v16
    v_pk_mul_f32 v[24:25], v[152:153], v[152:153]
    v_rcp_f32 v17, v17
    v_pk_mul_f32 v[26:27], v[154:155], v[154:155]
    v_pk_mul_f32 v[28:29], v[156:157], v[156:157]
    v_rcp_f32 v18, v18
    v_pk_mul_f32 v[30:31], v[158:159], v[158:159]
    v_rcp_f32 v19, v19
    v_pk_fma_f32 v[24:25], v[24:25], v[12:13], v[8:9]
    v_pk_fma_f32 v[26:27], v[26:27], v[12:13], v[8:9]
    v_rcp_f32 v20, v20
    v_pk_fma_f32 v[28:29], v[28:29], v[12:13], v[8:9]
    v_rcp_f32 v21, v21
    v_pk_fma_f32 v[30:31], v[30:31], v[12:13], v[8:9]
    v_pk_mul_f32 v[24:25], v[24:25], v[152:153]
    v_rcp_f32 v22, v22
    v_pk_mul_f32 v[26:27], v[26:27], v[154:155]
    v_rcp_f32 v23, v23
    v_pk_mul_f32 v[28:29], v[28:29], v[156:157]
    v_pk_mul_f32 v[30:31], v[30:31], v[158:159]
    v_exp_f32 v24, v24
    v_pk_mul_f32 v[16:17], v[16:17], v[144:145]
    v_exp_f32 v25, v25
    v_pk_mul_f32 v[18:19], v[18:19], v[146:147]
    v_exp_f32 v26, v26
    v_pk_mul_f32 v[20:21], v[20:21], v[148:149]
    v_exp_f32 v27, v27
    v_pk_mul_f32 v[22:23], v[22:23], v[150:151]
    v_exp_f32 v28, v28
    v_cvt_pk_bf16_f32 v52, v16, v17
    v_exp_f32 v29, v29
    v_cvt_pk_bf16_f32 v53, v18, v19
    v_exp_f32 v30, v30
    v_cvt_pk_bf16_f32 v54, v20, v21
    v_exp_f32 v31, v31
    v_cvt_pk_bf16_f32 v55, v22, v23
    buffer_store_dwordx4 v[52:55], v1, s[52:55], s8 offen offset:1536 sc1
    s_waitcnt vmcnt(4)
    s_mov_b64 exec, 0xff
    buffer_atomic_or v14, v15, s[52:55], s12 offen sc1
    s_mov_b64 exec, -1
    s_load_dword s68, s[48:49], s69 glc
    v_pk_fma_f32 v[24:25], v[24:25], v[10:11], v[10:11]
    v_pk_fma_f32 v[26:27], v[26:27], v[10:11], v[10:11]
    v_pk_fma_f32 v[28:29], v[28:29], v[10:11], v[10:11]
    v_pk_fma_f32 v[30:31], v[30:31], v[10:11], v[10:11]
    v_rcp_f32 v24, v24
    v_pk_mul_f32 v[32:33], v[160:161], v[160:161]
    v_rcp_f32 v25, v25
    v_pk_mul_f32 v[34:35], v[162:163], v[162:163]
    v_pk_mul_f32 v[36:37], v[164:165], v[164:165]
    v_rcp_f32 v26, v26
    v_pk_mul_f32 v[38:39], v[166:167], v[166:167]
    v_rcp_f32 v27, v27
    v_pk_fma_f32 v[32:33], v[32:33], v[12:13], v[8:9]
    v_pk_fma_f32 v[34:35], v[34:35], v[12:13], v[8:9]
    v_rcp_f32 v28, v28
    v_pk_fma_f32 v[36:37], v[36:37], v[12:13], v[8:9]
    v_rcp_f32 v29, v29
    v_pk_fma_f32 v[38:39], v[38:39], v[12:13], v[8:9]
    v_pk_mul_f32 v[32:33], v[32:33], v[160:161]
    v_rcp_f32 v30, v30
    v_pk_mul_f32 v[34:35], v[34:35], v[162:163]
    v_rcp_f32 v31, v31
    v_pk_mul_f32 v[36:37], v[36:37], v[164:165]
    v_pk_mul_f32 v[38:39], v[38:39], v[166:167]
    v_exp_f32 v32, v32
    v_pk_mul_f32 v[24:25], v[24:25], v[152:153]
    v_exp_f32 v33, v33
    v_pk_mul_f32 v[26:27], v[26:27], v[154:155]
    v_exp_f32 v34, v34
    v_pk_mul_f32 v[28:29], v[28:29], v[156:157]
    v_exp_f32 v35, v35
    v_pk_mul_f32 v[30:31], v[30:31], v[158:159]
    v_exp_f32 v36, v36
    v_cvt_pk_bf16_f32 v56, v24, v25
    v_exp_f32 v37, v37
    v_cvt_pk_bf16_f32 v57, v26, v27
    v_exp_f32 v38, v38
    v_cvt_pk_bf16_f32 v58, v28, v29
    v_exp_f32 v39, v39
    v_cvt_pk_bf16_f32 v59, v30, v31
    buffer_store_dwordx4 v[56:59], v1, s[52:55], s8 offen offset:2048 sc1
    v_pk_fma_f32 v[32:33], v[32:33], v[10:11], v[10:11]
    v_pk_fma_f32 v[34:35], v[34:35], v[10:11], v[10:11]
    v_pk_fma_f32 v[36:37], v[36:37], v[10:11], v[10:11]
    v_pk_fma_f32 v[38:39], v[38:39], v[10:11], v[10:11]
    s_load_dword s14, s[48:49], s34 glc
    v_rcp_f32 v32, v32
    v_rcp_f32 v33, v33
    v_rcp_f32 v34, v34
    v_rcp_f32 v35, v35
    v_rcp_f32 v36, v36
    v_rcp_f32 v37, v37
    v_rcp_f32 v38, v38
    v_rcp_f32 v39, v39
    v_pk_mul_f32 v[32:33], v[32:33], v[160:161]
    v_pk_mul_f32 v[34:35], v[34:35], v[162:163]
    v_pk_mul_f32 v[36:37], v[36:37], v[164:165]
    v_pk_mul_f32 v[38:39], v[38:39], v[166:167]
    v_cvt_pk_bf16_f32 v60, v32, v33
    v_cvt_pk_bf16_f32 v61, v34, v35
    v_cvt_pk_bf16_f32 v62, v36, v37
    v_cvt_pk_bf16_f32 v63, v38, v39
    buffer_store_dwordx4 v[60:63], v1, s[52:55], s8 offen offset:2560 sc1
    v_mov_b32 v2, 163464
    v_mov_b32 v3, 1
    ds_write_b32 v2, v3
    v_add_u32 v10, 0, v0
    v_mul_u32_u24 v11, 6554, v10
    v_lshrrev_b32 v11, 16, v11
    v_mul_u32_u24 v11, 1120, v11
    v_lshl_add_u32 v8, v10, 4, v11
    v_add_u32 v10, 64, v0
    v_mul_u32_u24 v11, 6554, v10
    v_lshrrev_b32 v11, 16, v11
    v_mul_u32_u24 v11, 1120, v11
    v_lshl_add_u32 v9, v10, 4, v11
    v_add_u32 v10, 128, v0
    v_mul_u32_u24 v11, 6554, v10
    v_lshrrev_b32 v11, 16, v11
    v_mul_u32_u24 v11, 1120, v11
    v_lshl_add_u32 v13, v10, 4, v11
    v_cmp_gt_u32 vcc, 32, v0
    v_mov_b32 v10, 0x7f000000
    s_nop 0
    v_cndmask_b32 v13, v10, v13, vcc
    s_mul_i32 s10, s4, 20480
    s_add_u32 m0, s10, 15360
    s_nop 0
    buffer_load_dwordx4 v8, s[56:59], s27 offen lds
    s_add_u32 m0, s10, 16384
    s_nop 0
    buffer_load_dwordx4 v9, s[56:59], s27 offen lds
    s_add_u32 m0, s10, 17408
    s_nop 0
    buffer_load_dwordx4 v13, s[56:59], s27 offen lds
    s_add_u32 m0, s10, 18432
    s_mov_b64 exec, 0x3ff
    buffer_load_dwordx4 v252, s[60:63], s29 offen lds
    s_mov_b64 exec, -1
    v_add_u32 v2, s10, v254
    v_add_u32 v3, s10, v255
    s_mov_b32 s35, 0
    s_mov_b32 s101, 0
    s_waitcnt lgkmcnt(0)
    s_cmp_eq_u32 s68, 0
    s_cbranch_scc1 L_c_slow
    buffer_load_dwordx4 v[164:167], v252, s[52:55], s22 offen offset:0 sc1
    buffer_load_dwordx4 v[168:171], v252, s[52:55], s23 offen offset:0 sc1
    buffer_load_dwordx4 v[172:175], v252, s[52:55], s24 offen offset:0 sc1
    buffer_load_dwordx4 v[176:179], v252, s[52:55], s25 offen offset:0 sc1
    buffer_load_dwordx4 v[180:183], v252, s[52:55], s26 offen offset:0 sc1
    s_and_b32 s13, s14, s28
    s_cmp_eq_u32 s13, s28
    s_cbranch_scc0 L_c_mid
    buffer_load_dwordx4 v[16:19], v252, s[52:55], s18 offen offset:0 sc1
    buffer_load_dwordx4 v[20:23], v252, s[52:55], s19 offen offset:0 sc1
    buffer_load_dwordx4 v[24:27], v252, s[52:55], s20 offen offset:0 sc1
    buffer_load_dwordx4 v[28:31], v252, s[52:55], s21 offen offset:0 sc1
    s_waitcnt vmcnt(13)
    s_mov_b64 exec, 0xff
    buffer_atomic_or v14, v15, s[52:55], s12 offen offset:64 sc1
    s_mov_b64 exec, -1
    buffer_load_dwordx4 v[184:187], v252, s[52:55], s22 offen offset:1024 sc1
    buffer_load_dwordx4 v[188:191], v252, s[52:55], s23 offen offset:1024 sc1
    buffer_load_dwordx4 v[192:195], v252, s[52:55], s24 offen offset:1024 sc1
    buffer_load_dwordx4 v[196:199], v252, s[52:55], s25 offen offset:1024 sc1
    buffer_load_dwordx4 v[200:203], v252, s[52:55], s26 offen offset:1024 sc1
    buffer_load_dwordx4 v[204:207], v252, s[52:55], s22 offen offset:2048 sc1
    buffer_load_dwordx4 v[208:211], v252, s[52:55], s23 offen offset:2048 sc1
    buffer_load_dwordx4 v[212:215], v252, s[52:55], s24 offen offset:2048 sc1
    buffer_load_dwordx4 v[216:219], v252, s[52:55], s25 offen offset:2048 sc1
    buffer_load_dwordx4 v[220:223], v252, s[52:55], s26 offen offset:2048 sc1
    buffer_load_dwordx4 v[144:147], v252, s[52:55], s22 offen offset:3072 sc1
    buffer_load_dwordx4 v[148:151], v252, s[52:55], s23 offen offset:3072 sc1
    buffer_load_dwordx4 v[152:155], v252, s[52:55], s24 offen offset:3072 sc1
    buffer_load_dwordx4 v[156:159], v252, s[52:55], s25 offen offset:3072 sc1
    buffer_load_dwordx4 v[160:163], v252, s[52:55], s26 offen offset:3072 sc1
    buffer_load_dwordx4 v[32:35], v252, s[52:55], s18 offen offset:1024 sc1
    buffer_load_dwordx4 v[36:39], v252, s[52:55], s19 offen offset:1024 sc1
    buffer_load_dwordx4 v[40:43], v252, s[52:55], s20 offen offset:1024 sc1
    buffer_load_dwordx4 v[44:47], v252, s[52:55], s21 offen offset:1024 sc1
    buffer_load_dwordx4 v[48:51], v252, s[52:55], s18 offen offset:2048 sc1
    buffer_load_dwordx4 v[52:55], v252, s[52:55], s19 offen offset:2048 sc1
    buffer_load_dwordx4 v[56:59], v252, s[52:55], s20 offen offset:2048 sc1
    buffer_load_dwordx4 v[60:63], v252, s[52:55], s21 offen offset:2048 sc1
    s_mov_b32 s101, 1
    s_waitcnt vmcnt(33)
    s_branch L_c_acc
L_c_mid:
    s_waitcnt vmcnt(9)
    s_mov_b64 exec, 0xff
    buffer_atomic_or v14, v15, s[52:55], s12 offen offset:64 sc1
    s_mov_b64 exec, -1
    buffer_load_dwordx4 v[184:187], v252, s[52:55], s22 offen offset:1024 sc1
    buffer_load_dwordx4 v[188:191], v252, s[52:55], s23 offen offset:1024 sc1
    buffer_load_dwordx4 v[192:195], v252, s[52:55], s24 offen offset:1024 sc1
    buffer_load_dwordx4 v[196:199], v252, s[52:55], s25 offen offset:1024 sc1
    buffer_load_dwordx4 v[200:203], v252, s[52:55], s26 offen offset:1024 sc1
    buffer_load_dwordx4 v[204:207], v252, s[52:55], s22 offen offset:2048 sc1
    buffer_load_dwordx4 v[208:211], v252, s[52:55], s23 offen offset:2048 sc1
    buffer_load_dwordx4 v[212:215], v252, s[52:55], s24 offen offset:2048 sc1
    buffer_load_dwordx4 v[216:219], v252, s[52:55], s25 offen offset:2048 sc1
    buffer_load_dwordx4 v[220:223], v252, s[52:55], s26 offen offset:2048 sc1
    buffer_load_dwordx4 v[144:147], v252, s[52:55], s22 offen offset:3072 sc1
    buffer_load_dwordx4 v[148:151], v252, s[52:55], s23 offen offset:3072 sc1
    buffer_load_dwordx4 v[152:155], v252, s[52:55], s24 offen offset:3072 sc1
    buffer_load_dwordx4 v[156:159], v252, s[52:55], s25 offen offset:3072 sc1
    buffer_load_dwordx4 v[160:163], v252, s[52:55], s26 offen offset:3072 sc1
    s_waitcnt vmcnt(21)
    s_branch L_c_acc
L_c_slow:
    s_waitcnt vmcnt(0)
    s_mov_b64 exec, 0xff
    buffer_atomic_or v14, v15, s[52:55], s12 offen offset:64 sc1
    s_mov_b64 exec, -1
L_c_acc:
    s_setprio 0
    ds_read_b64 v[224:225], v2 offset:15360
    ds_read_b64 v[234:235], v3 offset:18432
    ds_read_b64 v[226:227], v2 offset:15392
    ds_read_b64 v[236:237], v3 offset:18464
    ds_read_b64 v[228:229], v2 offset:15424
    ds_read_b64 v[238:239], v3 offset:18496
    ds_read_b64 v[230:231], v2 offset:15456
    ds_read_b64 v[240:241], v3 offset:18528
    ds_read_b64 v[232:233], v2 offset:15488
    ds_read_b64 v[242:243], v3 offset:18560
    s_waitcnt lgkmcnt(0)
    v_lshlrev_b32 v64, 16, v224
    v_and_b32 v65, 0xffff0000, v224
    v_lshlrev_b32 v10, 16, v234
    v_and_b32 v11, 0xffff0000, v234
    v_add_f32 v64, v64, v10
    v_add_f32 v65, v65, v11
    v_lshlrev_b32 v66, 16, v225
    v_and_b32 v67, 0xffff0000, v225
    v_lshlrev_b32 v10, 16, v235
    v_and_b32 v11, 0xffff0000, v235
    v_add_f32 v66, v66, v10
    v_add_f32 v67, v67, v11
    v_lshlrev_b32 v68, 16, v226
    v_and_b32 v69, 0xffff0000, v226
    v_lshlrev_b32 v10, 16, v236
    v_and_b32 v11, 0xffff0000, v236
    v_add_f32 v68, v68, v10
    v_add_f32 v69, v69, v11
    v_lshlrev_b32 v70, 16, v227
    v_and_b32 v71, 0xffff0000, v227
    v_lshlrev_b32 v10, 16, v237
    v_and_b32 v11, 0xffff0000, v237
    v_add_f32 v70, v70, v10
    v_add_f32 v71, v71, v11
    v_lshlrev_b32 v72, 16, v228
    v_and_b32 v73, 0xffff0000, v228
    v_lshlrev_b32 v10, 16, v238
    v_and_b32 v11, 0xffff0000, v238
    v_add_f32 v72, v72, v10
    v_add_f32 v73, v73, v11
    v_lshlrev_b32 v74, 16, v229
    v_and_b32 v75, 0xffff0000, v229
    v_lshlrev_b32 v10, 16, v239
    v_and_b32 v11, 0xffff0000, v239
    v_add_f32 v74, v74, v10
    v_add_f32 v75, v75, v11
    v_lshlrev_b32 v76, 16, v230
    v_and_b32 v77, 0xffff0000, v230
    v_lshlrev_b32 v10, 16, v240
    v_and_b32 v11, 0xffff0000, v240
    v_add_f32 v76, v76, v10
    v_add_f32 v77, v77, v11
    v_lshlrev_b32 v78, 16, v231
    v_and_b32 v79, 0xffff0000, v231
    v_lshlrev_b32 v10, 16, v241
    v_and_b32 v11, 0xffff0000, v241
    v_add_f32 v78, v78, v10
    v_add_f32 v79, v79, v11
    v_lshlrev_b32 v80, 16, v232
    v_and_b32 v81, 0xffff0000, v232
    v_lshlrev_b32 v10, 16, v242
    v_and_b32 v11, 0xffff0000, v242
    v_add_f32 v80, v80, v10
    v_add_f32 v81, v81, v11
    v_lshlrev_b32 v82, 16, v233
    v_and_b32 v83, 0xffff0000, v233
    v_lshlrev_b32 v10, 16, v243
    v_and_b32 v11, 0xffff0000, v243
    v_add_f32 v82, v82, v10
    v_add_f32 v83, v83, v11
    s_cmp_lg_u32 s68, 0
    s_cbranch_scc1 L_g2go
    s_branch L_g2w
L_g2:
    s_lshl_b32 s30, s5, 3
    s_lshr_b32 s31, s7, 2
    s_add_u32 s30, s30, s31
    s_lshl_b32 s31, s6, 2
    s_and_b32 s29, s7, 3
    s_add_u32 s31, s31, s29
    s_mul_i32 s28, s4, 7168
    s_max_u32 s28, s28, 1024
    s_sub_u32 s28, s28, 1024
    s_mul_i32 s27, s30, 221184
    s_add_u32 s27, s27, s28
    s_add_u32 s27, s27, 10485760
    s_add_u32 s29, s4, 0
    s_and_b32 s29, s29, 3
    s_mul_i32 s29, s29, 55296
    s_add_u32 s18, s27, s29
    s_add_u32 s29, s4, 1
    s_and_b32 s29, s29, 3
    s_mul_i32 s29, s29, 55296
    s_add_u32 s19, s27, s29
    s_add_u32 s29, s4, 2
    s_and_b32 s29, s29, 3
    s_mul_i32 s29, s29, 55296
    s_add_u32 s20, s27, s29
    s_add_u32 s29, s4, 3
    s_and_b32 s29, s29, 3
    s_mul_i32 s29, s29, 55296
    s_add_u32 s21, s27, s29
    s_mul_i32 s22, s31, 276480
    s_add_u32 s22, s22, s28
    s_add_u32 s22, s22, 7864320
    s_add_u32 s23, s22, 55296
    s_add_u32 s24, s22, 110592
    s_add_u32 s25, s22, 165888
    s_add_u32 s26, s22, 221184
    s_lshl_b32 s27, s30, 6
    s_lshl_b32 s29, s4, 4
    s_add_u32 s27, s27, s29
    s_mul_i32 s27, s27, 1280
    s_mul_i32 s29, s31, 160
    s_add_u32 s27, s27, s29
    s_mov_b32 s28, 0x1803
    s_cmp_eq_u32 s4, 1
    s_cselect_b32 s28, 0xe01c, s28
    s_cmp_eq_u32 s4, 2
    s_cselect_b32 s28, 0x38070, s28
    s_cmp_eq_u32 s4, 3
    s_cselect_b32 s28, 0xe01c0, s28
    v_lshlrev_b32 v252, 4, v0
    s_cmp_eq_u32 s4, 0
    s_cselect_b32 s30, 0x7f000000, 0
    v_add_u32 v253, s30, v252
    v_lshrrev_b32 v255, 4, v0
    v_lshlrev_b32 v255, 3, v255
    v_and_b32 v254, 15, v0
    v_mul_u32_u24 v254, 160, v254
    v_add_u32 v254, v254, v255
    s_mov_b32 s60, s42
    s_mov_b32 s61, s43
    s_mov_b32 s62, 0x500
    s_mov_b32 s63, 0x20000
    s_mov_b32 s101, 0
    v_add_u32 v10, 0, v0
    v_mul_u32_u24 v11, 6554, v10
    v_lshrrev_b32 v11, 16, v11
    v_mul_u32_u24 v11, 1120, v11
    v_lshl_add_u32 v8, v10, 4, v11
    v_add_u32 v10, 64, v0
    v_mul_u32_u24 v11, 6554, v10
    v_lshrrev_b32 v11, 16, v11
    v_mul_u32_u24 v11, 1120, v11
    v_lshl_add_u32 v9, v10, 4, v11
    v_add_u32 v10, 128, v0
    v_mul_u32_u24 v11, 6554, v10
    v_lshrrev_b32 v11, 16, v11
    v_mul_u32_u24 v11, 1120, v11
    v_lshl_add_u32 v13, v10, 4, v11
    v_cmp_gt_u32 vcc, 32, v0
    v_mov_b32 v10, 0x7f000000
    s_nop 0
    v_cndmask_b32 v13, v10, v13, vcc
    s_mul_i32 s10, s4, 20480
    s_add_u32 m0, s10, 15360
    s_nop 0
    buffer_load_dwordx4 v8, s[56:59], s27 offen lds
    s_add_u32 m0, s10, 16384
    s_nop 0
    buffer_load_dwordx4 v9, s[56:59], s27 offen lds
    s_add_u32 m0, s10, 17408
    s_nop 0
    buffer_load_dwordx4 v13, s[56:59], s27 offen lds
    s_add_u32 m0, s10, 18432
    s_mov_b64 exec, 0x3ff
    buffer_load_dwordx4 v252, s[60:63], s29 offen lds
    s_mov_b64 exec, -1
    v_add_u32 v2, s10, v254
    v_add_u32 v3, s10, v255
    s_waitcnt vmcnt(0)
    ds_read_b64 v[224:225], v2 offset:15360
    ds_read_b64 v[234:235], v3 offset:18432
    ds_read_b64 v[226:227], v2 offset:15392
    ds_read_b64 v[236:237], v3 offset:18464
    ds_read_b64 v[228:229], v2 offset:15424
    ds_read_b64 v[238:239], v3 offset:18496
    ds_read_b64 v[230:231], v2 offset:15456
    ds_read_b64 v[240:241], v3 offset:18528
    ds_read_b64 v[232:233], v2 offset:15488
    ds_read_b64 v[242:243], v3 offset:18560
    s_waitcnt lgkmcnt(0)
    v_lshlrev_b32 v64, 16, v224
    v_and_b32 v65, 0xffff0000, v224
    v_lshlrev_b32 v10, 16, v234
    v_and_b32 v11, 0xffff0000, v234
    v_add_f32 v64, v64, v10
    v_add_f32 v65, v65, v11
    v_lshlrev_b32 v66, 16, v225
    v_and_b32 v67, 0xffff0000, v225
    v_lshlrev_b32 v10, 16, v235
    v_and_b32 v11, 0xffff0000, v235
    v_add_f32 v66, v66, v10
    v_add_f32 v67, v67, v11
    v_lshlrev_b32 v68, 16, v226
    v_and_b32 v69, 0xffff0000, v226
    v_lshlrev_b32 v10, 16, v236
    v_and_b32 v11, 0xffff0000, v236
    v_add_f32 v68, v68, v10
    v_add_f32 v69, v69, v11
    v_lshlrev_b32 v70, 16, v227
    v_and_b32 v71, 0xffff0000, v227
    v_lshlrev_b32 v10, 16, v237
    v_and_b32 v11, 0xffff0000, v237
    v_add_f32 v70, v70, v10
    v_add_f32 v71, v71, v11
    v_lshlrev_b32 v72, 16, v228
    v_and_b32 v73, 0xffff0000, v228
    v_lshlrev_b32 v10, 16, v238
    v_and_b32 v11, 0xffff0000, v238
    v_add_f32 v72, v72, v10
    v_add_f32 v73, v73, v11
    v_lshlrev_b32 v74, 16, v229
    v_and_b32 v75, 0xffff0000, v229
    v_lshlrev_b32 v10, 16, v239
    v_and_b32 v11, 0xffff0000, v239
    v_add_f32 v74, v74, v10
    v_add_f32 v75, v75, v11
    v_lshlrev_b32 v76, 16, v230
    v_and_b32 v77, 0xffff0000, v230
    v_lshlrev_b32 v10, 16, v240
    v_and_b32 v11, 0xffff0000, v240
    v_add_f32 v76, v76, v10
    v_add_f32 v77, v77, v11
    v_lshlrev_b32 v78, 16, v231
    v_and_b32 v79, 0xffff0000, v231
    v_lshlrev_b32 v10, 16, v241
    v_and_b32 v11, 0xffff0000, v241
    v_add_f32 v78, v78, v10
    v_add_f32 v79, v79, v11
    v_lshlrev_b32 v80, 16, v232
    v_and_b32 v81, 0xffff0000, v232
    v_lshlrev_b32 v10, 16, v242
    v_and_b32 v11, 0xffff0000, v242
    v_add_f32 v80, v80, v10
    v_add_f32 v81, v81, v11
    v_lshlrev_b32 v82, 16, v233
    v_and_b32 v83, 0xffff0000, v233
    v_lshlrev_b32 v10, 16, v243
    v_and_b32 v11, 0xffff0000, v243
    v_add_f32 v82, v82, v10
    v_add_f32 v83, v83, v11
L_g2w:
    s_and_b32 s8, s2, 31
    s_lshl_b32 s8, s8, 7
    s_add_u32 s8, s8, 10208256
    s_load_dword s9, s[48:49], s8 glc
L_spoll_5:
    s_waitcnt lgkmcnt(0)
    s_cmp_lg_u32 s9, 0
    s_cbranch_scc1 L_sdone_6
    s_add_u32 s50, s50, 1
    s_cmp_gt_u32 s50, 100000
    s_cbranch_scc1 L_exit
    s_sleep 16
    s_load_dword s9, s[48:49], s8 glc
    s_branch L_spoll_5
L_sdone_6:
    s_cmp_eq_u32 s35, 0
    s_cbranch_scc1 L_g_nopark
    s_mul_i32 s10, s4, 20480
    s_add_u32 m0, s10, 0
    s_add_u32 s13, s22, 28672
    buffer_load_dwordx4 v252, s[52:55], s13 offen sc1 lds
    s_add_u32 m0, s10, 1024
    s_add_u32 s13, s23, 28672
    buffer_load_dwordx4 v252, s[52:55], s13 offen sc1 lds
    s_add_u32 m0, s10, 2048
    s_add_u32 s13, s24, 28672
    buffer_load_dwordx4 v252, s[52:55], s13 offen sc1 lds
    s_add_u32 m0, s10, 3072
    s_add_u32 s13, s25, 28672
    buffer_load_dwordx4 v252, s[52:55], s13 offen sc1 lds
    s_add_u32 m0, s10, 4096
    s_add_u32 s13, s26, 28672
    buffer_load_dwordx4 v252, s[52:55], s13 offen sc1 lds
    s_add_u32 m0, s10, 5120
    s_add_u32 s13, s22, 30720
    buffer_load_dwordx4 v252, s[52:55], s13 offen sc1 lds
    s_add_u32 m0, s10, 6144
    s_add_u32 s13, s23, 30720
    buffer_load_dwordx4 v252, s[52:55], s13 offen sc1 lds
    s_add_u32 m0, s10, 7168
    s_add_u32 s13, s24, 30720
    buffer_load_dwordx4 v252, s[52:55], s13 offen sc1 lds
    s_add_u32 m0, s10, 8192
    s_add_u32 s13, s25, 30720
    buffer_load_dwordx4 v252, s[52:55], s13 offen sc1 lds
    s_add_u32 m0, s10, 9216
    s_add_u32 s13, s26, 30720
    buffer_load_dwordx4 v252, s[52:55], s13 offen sc1 lds
    s_add_u32 m0, s10, 10240
    s_add_u32 s13, s22, 32768
    buffer_load_dwordx4 v252, s[52:55], s13 offen sc1 lds
    s_add_u32 m0, s10, 11264
    s_add_u32 s13, s23, 32768
    buffer_load_dwordx4 v252, s[52:55], s13 offen sc1 lds
    s_add_u32 m0, s10, 12288
    s_add_u32 s13, s24, 32768
    buffer_load_dwordx4 v252, s[52:55], s13 offen sc1 lds
    s_add_u32 m0, s10, 13312
    s_add_u32 s13, s25, 32768
    buffer_load_dwordx4 v252, s[52:55], s13 offen sc1 lds
    s_add_u32 m0, s10, 14336
    s_add_u32 s13, s26, 32768
    buffer_load_dwordx4 v252, s[52:55], s13 offen sc1 lds
L_g_nopark:
    buffer_load_dwordx4 v[164:167], v252, s[52:55], s22 offen offset:0 sc1
    buffer_load_dwordx4 v[168:171], v252, s[52:55], s23 offen offset:0 sc1
    buffer_load_dwordx4 v[172:175], v252, s[52:55], s24 offen offset:0 sc1
    buffer_load_dwordx4 v[176:179], v252, s[52:55], s25 offen offset:0 sc1
    buffer_load_dwordx4 v[180:183], v252, s[52:55], s26 offen offset:0 sc1
    buffer_load_dwordx4 v[184:187], v252, s[52:55], s22 offen offset:1024 sc1
    buffer_load_dwordx4 v[188:191], v252, s[52:55], s23 offen offset:1024 sc1
    buffer_load_dwordx4 v[192:195], v252, s[52:55], s24 offen offset:1024 sc1
    buffer_load_dwordx4 v[196:199], v252, s[52:55], s25 offen offset:1024 sc1
    buffer_load_dwordx4 v[200:203], v252, s[52:55], s26 offen offset:1024 sc1
    buffer_load_dwordx4 v[204:207], v252, s[52:55], s22 offen offset:2048 sc1
    buffer_load_dwordx4 v[208:211], v252, s[52:55], s23 offen offset:2048 sc1
    buffer_load_dwordx4 v[212:215], v252, s[52:55], s24 offen offset:2048 sc1
    buffer_load_dwordx4 v[216:219], v252, s[52:55], s25 offen offset:2048 sc1
    buffer_load_dwordx4 v[220:223], v252, s[52:55], s26 offen offset:2048 sc1
    buffer_load_dwordx4 v[144:147], v252, s[52:55], s22 offen offset:3072 sc1
    buffer_load_dwordx4 v[148:151], v252, s[52:55], s23 offen offset:3072 sc1
    buffer_load_dwordx4 v[152:155], v252, s[52:55], s24 offen offset:3072 sc1
    buffer_load_dwordx4 v[156:159], v252, s[52:55], s25 offen offset:3072 sc1
    buffer_load_dwordx4 v[160:163], v252, s[52:55], s26 offen offset:3072 sc1
L_g2go:
    s_cmp_lg_u32 s101, 0
    s_cbranch_scc1 L_g_nohm
    s_load_dword s14, s[48:49], s34 glc
L_g_nohm:
    s_mul_i32 s10, s4, 20480
    v_add_u32 v1, s10, v252
    s_sub_u32 s13, s4, 1
    s_and_b32 s13, s13, 3
    s_mul_i32 s13, s13, 20480
    s_add_u32 s13, s13, 0
    v_add_u32 v2, s13, v252
    s_sub_u32 s13, s4, 2
    s_and_b32 s13, s13, 3
    s_mul_i32 s13, s13, 20480
    s_add_u32 s13, s13, 5120
    v_add_u32 v3, s13, v252
    s_sub_u32 s13, s4, 3
    s_and_b32 s13, s13, 3
    s_mul_i32 s13, s13, 20480
    s_add_u32 s13, s13, 10240
    v_add_u32 v4, s13, v252
    v_lshrrev_b32 v10, 2, v0
    v_lshlrev_b32 v10, 7, v10
    v_bfe_u32 v15, v0, 1, 1
    v_lshl_add_u32 v10, v15, 6, v10
    v_and_b32 v15, 1, v0
    v_lshl_add_u32 v10, v15, 3, v10
    s_lshl_b32 s13, s4, 4
    s_add_u32 s13, s13, 143360
    v_add_u32 v5, s13, v10
    s_mul_i32 s13, s4, 2560
    s_add_u32 s13, s13, 81920
    v_add_u32 v6, s13, v254
    v_add_u32 v7, s13, v252
    v_mov_b32 v14, 163456
    s_mov_b32 s56, s44
    s_mov_b32 s57, s45
    s_mov_b32 s58, 0x280000
    s_mov_b32 s59, 0x20000
    s_cmp_lg_u32 s101, 0
    s_cbranch_scc1 L_g_fast
L_spoll_7:
    s_waitcnt lgkmcnt(0)
    s_and_b32 s13, s14, s28
    s_cmp_eq_u32 s13, s28
    s_cbranch_scc1 L_sdone_8
    s_add_u32 s50, s50, 1
    s_cmp_gt_u32 s50, 100000
    s_cbranch_scc1 L_exit
    s_sleep 4
    s_and_b32 s13, s14, 0x3fffff
    s_cbranch_scc1 L_near_9
    s_sleep 28
L_near_9:
    s_load_dword s14, s[48:49], s34 glc
    s_branch L_spoll_7
L_sdone_8:
    buffer_load_dwordx4 v[16:19], v252, s[52:55], s18 offen offset:0 sc1
    buffer_load_dwordx4 v[20:23], v252, s[52:55], s19 offen offset:0 sc1
    buffer_load_dwordx4 v[24:27], v252, s[52:55], s20 offen offset:0 sc1
    buffer_load_dwordx4 v[28:31], v252, s[52:55], s21 offen offset:0 sc1
    buffer_load_dwordx4 v[32:35], v252, s[52:55], s18 offen offset:1024 sc1
    buffer_load_dwordx4 v[36:39], v252, s[52:55], s19 offen offset:1024 sc1
    buffer_load_dwordx4 v[40:43], v252, s[52:55], s20 offen offset:1024 sc1
    buffer_load_dwordx4 v[44:47], v252, s[52:55], s21 offen offset:1024 sc1
    buffer_load_dwordx4 v[48:51], v252, s[52:55], s18 offen offset:2048 sc1
    buffer_load_dwordx4 v[52:55], v252, s[52:55], s19 offen offset:2048 sc1
    buffer_load_dwordx4 v[56:59], v252, s[52:55], s20 offen offset:2048 sc1
    buffer_load_dwordx4 v[60:63], v252, s[52:55], s21 offen offset:2048 sc1
    s_waitcnt vmcnt(8)
L_g_fast:
    s_add_u32 s15, s34, 64
    s_waitcnt vmcnt(24)
    v_mfma_f32_16x16x32_bf16 v[64:67], v[164:167], v[16:19], v[64:67]
    buffer_load_dwordx4 v[224:227], v252, s[52:55], s18 offen offset:3072 sc1
    v_mfma_f32_16x16x32_bf16 v[68:71], v[168:171], v[16:19], v[68:71]
    buffer_load_dwordx4 v[228:231], v252, s[52:55], s19 offen offset:3072 sc1
    v_mfma_f32_16x16x32_bf16 v[72:75], v[172:175], v[16:19], v[72:75]
    buffer_load_dwordx4 v[232:235], v252, s[52:55], s20 offen offset:3072 sc1
    v_mfma_f32_16x16x32_bf16 v[76:79], v[176:179], v[16:19], v[76:79]
    buffer_load_dwordx4 v[236:239], v252, s[52:55], s21 offen offset:3072 sc1
    v_mfma_f32_16x16x32_bf16 v[80:83], v[180:183], v[16:19], v[80:83]
    v_mfma_f32_16x16x32_bf16 v[84:87], v[164:167], v[20:23], 0
    v_mfma_f32_16x16x32_bf16 v[88:91], v[168:171], v[20:23], 0
    v_mfma_f32_16x16x32_bf16 v[92:95], v[172:175], v[20:23], 0
    v_mfma_f32_16x16x32_bf16 v[96:99], v[176:179], v[20:23], 0
    v_mfma_f32_16x16x32_bf16 v[100:103], v[180:183], v[20:23], 0
    v_mfma_f32_16x16x32_bf16 v[104:107], v[164:167], v[24:27], 0
    v_mfma_f32_16x16x32_bf16 v[108:111], v[168:171], v[24:27], 0
    v_mfma_f32_16x16x32_bf16 v[112:115], v[172:175], v[24:27], 0
    v_mfma_f32_16x16x32_bf16 v[116:119], v[176:179], v[24:27], 0
    v_mfma_f32_16x16x32_bf16 v[120:123], v[180:183], v[24:27], 0
    v_mfma_f32_16x16x32_bf16 v[124:127], v[164:167], v[28:31], 0
    v_mfma_f32_16x16x32_bf16 v[128:131], v[168:171], v[28:31], 0
    v_mfma_f32_16x16x32_bf16 v[132:135], v[172:175], v[28:31], 0
    v_mfma_f32_16x16x32_bf16 v[136:139], v[176:179], v[28:31], 0
    v_mfma_f32_16x16x32_bf16 v[140:143], v[180:183], v[28:31], 0
    s_add_u32 s18, s18, 4096
    s_add_u32 s19, s19, 4096
    s_add_u32 s20, s20, 4096
    s_add_u32 s21, s21, 4096
    s_add_u32 s22, s22, 4096
    s_add_u32 s23, s23, 4096
    s_add_u32 s24, s24, 4096
    s_add_u32 s25, s25, 4096
    s_add_u32 s26, s26, 4096
    s_waitcnt vmcnt(8)
    v_mfma_f32_16x16x32_bf16 v[64:67], v[184:187], v[32:35], v[64:67]
    buffer_load_dwordx4 v[16:19], v252, s[52:55], s18 offen offset:0 sc1
    v_mfma_f32_16x16x32_bf16 v[68:71], v[188:191], v[32:35], v[68:71]
    buffer_load_dwordx4 v[20:23], v252, s[52:55], s19 offen offset:0 sc1
    v_mfma_f32_16x16x32_bf16 v[72:75], v[192:195], v[32:35], v[72:75]
    buffer_load_dwordx4 v[24:27], v252, s[52:55], s20 offen offset:0 sc1
    v_mfma_f32_16x16x32_bf16 v[76:79], v[196:199], v[32:35], v[76:79]
    buffer_load_dwordx4 v[28:31], v252, s[52:55], s21 offen offset:0 sc1
    v_mfma_f32_16x16x32_bf16 v[80:83], v[200:203], v[32:35], v[80:83]
    buffer_load_dwordx4 v[164:167], v252, s[52:55], s22 offen offset:0 sc1
    v_mfma_f32_16x16x32_bf16 v[84:87], v[184:187], v[36:39], v[84:87]
    buffer_load_dwordx4 v[168:171], v252, s[52:55], s23 offen offset:0 sc1
    v_mfma_f32_16x16x32_bf16 v[88:91], v[188:191], v[36:39], v[88:91]
    buffer_load_dwordx4 v[172:175], v252, s[52:55], s24 offen offset:0 sc1
    v_mfma_f32_16x16x32_bf16 v[92:95], v[192:195], v[36:39], v[92:95]
    buffer_load_dwordx4 v[176:179], v252, s[52:55], s25 offen offset:0 sc1
    v_mfma_f32_16x16x32_bf16 v[96:99], v[196:199], v[36:39], v[96:99]
    buffer_load_dwordx4 v[180:183], v252, s[52:55], s26 offen offset:0 sc1
    v_mfma_f32_16x16x32_bf16 v[100:103], v[200:203], v[36:39], v[100:103]
    v_mfma_f32_16x16x32_bf16 v[104:107], v[184:187], v[40:43], v[104:107]
    v_mfma_f32_16x16x32_bf16 v[108:111], v[188:191], v[40:43], v[108:111]
    v_mfma_f32_16x16x32_bf16 v[112:115], v[192:195], v[40:43], v[112:115]
    v_mfma_f32_16x16x32_bf16 v[116:119], v[196:199], v[40:43], v[116:119]
    v_mfma_f32_16x16x32_bf16 v[120:123], v[200:203], v[40:43], v[120:123]
    v_mfma_f32_16x16x32_bf16 v[124:127], v[184:187], v[44:47], v[124:127]
    v_mfma_f32_16x16x32_bf16 v[128:131], v[188:191], v[44:47], v[128:131]
    v_mfma_f32_16x16x32_bf16 v[132:135], v[192:195], v[44:47], v[132:135]
    v_mfma_f32_16x16x32_bf16 v[136:139], v[196:199], v[44:47], v[136:139]
    v_mfma_f32_16x16x32_bf16 v[140:143], v[200:203], v[44:47], v[140:143]
    s_load_dword s14, s[48:49], s15 glc
    s_waitcnt vmcnt(13)
    v_mfma_f32_16x16x32_bf16 v[64:67], v[204:207], v[48:51], v[64:67]
    buffer_load_dwordx4 v[32:35], v252, s[52:55], s18 offen offset:1024 sc1
    v_mfma_f32_16x16x32_bf16 v[68:71], v[208:211], v[48:51], v[68:71]
    buffer_load_dwordx4 v[36:39], v252, s[52:55], s19 offen offset:1024 sc1
    v_mfma_f32_16x16x32_bf16 v[72:75], v[212:215], v[48:51], v[72:75]
    buffer_load_dwordx4 v[40:43], v252, s[52:55], s20 offen offset:1024 sc1
    v_mfma_f32_16x16x32_bf16 v[76:79], v[216:219], v[48:51], v[76:79]
    buffer_load_dwordx4 v[44:47], v252, s[52:55], s21 offen offset:1024 sc1
    v_mfma_f32_16x16x32_bf16 v[80:83], v[220:223], v[48:51], v[80:83]
    buffer_load_dwordx4 v[184:187], v252, s[52:55], s22 offen offset:1024 sc1
    v_mfma_f32_16x16x32_bf16 v[84:87], v[204:207], v[52:55], v[84:87]
    buffer_load_dwordx4 v[188:191], v252, s[52:55], s23 offen offset:1024 sc1
    v_mfma_f32_16x16x32_bf16 v[88:91], v[208:211], v[52:55], v[88:91]
    buffer_load_dwordx4 v[192:195], v252, s[52:55], s24 offen offset:1024 sc1
    v_mfma_f32_16x16x32_bf16 v[92:95], v[212:215], v[52:55], v[92:95]
    buffer_load_dwordx4 v[196:199], v252, s[52:55], s25 offen offset:1024 sc1
    v_mfma_f32_16x16x32_bf16 v[96:99], v[216:219], v[52:55], v[96:99]
    buffer_load_dwordx4 v[200:203], v252, s[52:55], s26 offen offset:1024 sc1
    v_mfma_f32_16x16x32_bf16 v[100:103], v[220:223], v[52:55], v[100:103]
    v_mfma_f32_16x16x32_bf16 v[104:107], v[204:207], v[56:59], v[104:107]
    v_mfma_f32_16x16x32_bf16 v[108:111], v[208:211], v[56:59], v[108:111]
    v_mfma_f32_16x16x32_bf16 v[112:115], v[212:215], v[56:59], v[112:115]
    v_mfma_f32_16x16x32_bf16 v[116:119], v[216:219], v[56:59], v[116:119]
    v_mfma_f32_16x16x32_bf16 v[120:123], v[220:223], v[56:59], v[120:123]
    v_mfma_f32_16x16x32_bf16 v[124:127], v[204:207], v[60:63], v[124:127]
    v_mfma_f32_16x16x32_bf16 v[128:131], v[208:211], v[60:63], v[128:131]
    v_mfma_f32_16x16x32_bf16 v[132:135], v[212:215], v[60:63], v[132:135]
    v_mfma_f32_16x16x32_bf16 v[136:139], v[216:219], v[60:63], v[136:139]
    v_mfma_f32_16x16x32_bf16 v[140:143], v[220:223], v[60:63], v[140:143]
    s_waitcnt vmcnt(18)
    v_mfma_f32_16x16x32_bf16 v[64:67], v[144:147], v[224:227], v[64:67]
    buffer_load_dwordx4 v[48:51], v253, s[52:55], s18 offen offset:2048 sc1
    v_mfma_f32_16x16x32_bf16 v[68:71], v[148:151], v[224:227], v[68:71]
    buffer_load_dwordx4 v[52:55], v253, s[52:55], s19 offen offset:2048 sc1
    v_mfma_f32_16x16x32_bf16 v[72:75], v[152:155], v[224:227], v[72:75]
    buffer_load_dwordx4 v[56:59], v253, s[52:55], s20 offen offset:2048 sc1
    v_mfma_f32_16x16x32_bf16 v[76:79], v[156:159], v[224:227], v[76:79]
    buffer_load_dwordx4 v[60:63], v253, s[52:55], s21 offen offset:2048 sc1
    v_mfma_f32_16x16x32_bf16 v[80:83], v[160:163], v[224:227], v[80:83]
    buffer_load_dwordx4 v[204:207], v253, s[52:55], s22 offen offset:2048 sc1
    v_mfma_f32_16x16x32_bf16 v[84:87], v[144:147], v[228:231], v[84:87]
    buffer_load_dwordx4 v[208:211], v253, s[52:55], s23 offen offset:2048 sc1
    v_mfma_f32_16x16x32_bf16 v[88:91], v[148:151], v[228:231], v[88:91]
    buffer_load_dwordx4 v[212:215], v253, s[52:55], s24 offen offset:2048 sc1
    v_mfma_f32_16x16x32_bf16 v[92:95], v[152:155], v[228:231], v[92:95]
    buffer_load_dwordx4 v[216:219], v253, s[52:55], s25 offen offset:2048 sc1
    v_mfma_f32_16x16x32_bf16 v[96:99], v[156:159], v[228:231], v[96:99]
    buffer_load_dwordx4 v[220:223], v253, s[52:55], s26 offen offset:2048 sc1
    v_mfma_f32_16x16x32_bf16 v[100:103], v[160:163], v[228:231], v[100:103]
    v_mfma_f32_16x16x32_bf16 v[104:107], v[144:147], v[232:235], v[104:107]
    v_mfma_f32_16x16x32_bf16 v[108:111], v[148:151], v[232:235], v[108:111]
    v_mfma_f32_16x16x32_bf16 v[112:115], v[152:155], v[232:235], v[112:115]
    v_mfma_f32_16x16x32_bf16 v[116:119], v[156:159], v[232:235], v[116:119]
    v_mfma_f32_16x16x32_bf16 v[120:123], v[160:163], v[232:235], v[120:123]
    v_mfma_f32_16x16x32_bf16 v[124:127], v[144:147], v[236:239], v[124:127]
    v_mfma_f32_16x16x32_bf16 v[128:131], v[148:151], v[236:239], v[128:131]
    v_mfma_f32_16x16x32_bf16 v[132:135], v[152:155], v[236:239], v[132:135]
    v_mfma_f32_16x16x32_bf16 v[136:139], v[156:159], v[236:239], v[136:139]
    v_mfma_f32_16x16x32_bf16 v[140:143], v[160:163], v[236:239], v[140:143]
L_spoll_10:
    s_waitcnt lgkmcnt(0)
    s_and_b32 s13, s14, s28
    s_cmp_eq_u32 s13, s28
    s_cbranch_scc1 L_sdone_11
    s_add_u32 s50, s50, 1
    s_cmp_gt_u32 s50, 100000
    s_cbranch_scc1 L_exit
    s_sleep 2
    s_load_dword s14, s[48:49], s15 glc
    s_branch L_spoll_10
L_sdone_11:
    s_add_u32 s18, s18, 23552
    s_add_u32 s19, s19, 23552
    s_add_u32 s20, s20, 23552
    s_add_u32 s21, s21, 23552
    s_add_u32 s22, s22, 23552
    s_add_u32 s23, s23, 23552
    s_add_u32 s24, s24, 23552
    s_add_u32 s25, s25, 23552
    s_add_u32 s26, s26, 23552
    s_waitcnt vmcnt(18)
    v_mfma_f32_16x16x32_bf16 v[64:67], v[164:167], v[16:19], v[64:67]
    buffer_load_dwordx4 v[224:227], v252, s[52:55], s18 offen offset:0 sc1
    v_mfma_f32_16x16x32_bf16 v[68:71], v[168:171], v[16:19], v[68:71]
    buffer_load_dwordx4 v[228:231], v252, s[52:55], s19 offen offset:0 sc1
    v_mfma_f32_16x16x32_bf16 v[72:75], v[172:175], v[16:19], v[72:75]
    buffer_load_dwordx4 v[232:235], v252, s[52:55], s20 offen offset:0 sc1
    v_mfma_f32_16x16x32_bf16 v[76:79], v[176:179], v[16:19], v[76:79]
    buffer_load_dwordx4 v[236:239], v252, s[52:55], s21 offen offset:0 sc1
    v_mfma_f32_16x16x32_bf16 v[80:83], v[180:183], v[16:19], v[80:83]
    buffer_load_dwordx4 v[144:147], v252, s[52:55], s22 offen offset:0 sc1
    v_mfma_f32_16x16x32_bf16 v[84:87], v[164:167], v[20:23], v[84:87]
    buffer_load_dwordx4 v[148:151], v252, s[52:55], s23 offen offset:0 sc1
    v_mfma_f32_16x16x32_bf16 v[88:91], v[168:171], v[20:23], v[88:91]
    buffer_load_dwordx4 v[152:155], v252, s[52:55], s24 offen offset:0 sc1
    v_mfma_f32_16x16x32_bf16 v[92:95], v[172:175], v[20:23], v[92:95]
    buffer_load_dwordx4 v[156:159], v252, s[52:55], s25 offen offset:0 sc1
    v_mfma_f32_16x16x32_bf16 v[96:99], v[176:179], v[20:23], v[96:99]
    buffer_load_dwordx4 v[160:163], v252, s[52:55], s26 offen offset:0 sc1
    v_mfma_f32_16x16x32_bf16 v[100:103], v[180:183], v[20:23], v[100:103]
    v_mfma_f32_16x16x32_bf16 v[104:107], v[164:167], v[24:27], v[104:107]
    v_mfma_f32_16x16x32_bf16 v[108:111], v[168:171], v[24:27], v[108:111]
    v_mfma_f32_16x16x32_bf16 v[112:115], v[172:175], v[24:27], v[112:115]
    v_mfma_f32_16x16x32_bf16 v[116:119], v[176:179], v[24:27], v[116:119]
    v_mfma_f32_16x16x32_bf16 v[120:123], v[180:183], v[24:27], v[120:123]
    v_mfma_f32_16x16x32_bf16 v[124:127], v[164:167], v[28:31], v[124:127]
    v_mfma_f32_16x16x32_bf16 v[128:131], v[168:171], v[28:31], v[128:131]
    v_mfma_f32_16x16x32_bf16 v[132:135], v[172:175], v[28:31], v[132:135]
    v_mfma_f32_16x16x32_bf16 v[136:139], v[176:179], v[28:31], v[136:139]
    v_mfma_f32_16x16x32_bf16 v[140:143], v[180:183], v[28:31], v[140:143]
    s_cmp_lg_u32 s35, 0
    s_cbranch_scc1 L_g_pok
    s_mov_b32 s3, 0
L_g_pw:
    s_add_u32 s3, s3, 1
    s_cmp_gt_u32 s3, 2000000
    s_cbranch_scc1 L_exit
    ds_read_b32 v10, v14
    s_waitcnt lgkmcnt(0)
    v_readfirstlane_b32 s13, v10
    s_nop 0
    s_cmp_eq_u32 s13, 0
    s_cbranch_scc1 L_g_pw
L_g_pok:
    s_waitcnt vmcnt(18)
    v_mfma_f32_16x16x32_bf16 v[64:67], v[184:187], v[32:35], v[64:67]
    buffer_load_dwordx4 v[16:19], v252, s[52:55], s18 offen offset:1024 sc1
    v_mfma_f32_16x16x32_bf16 v[68:71], v[188:191], v[32:35], v[68:71]
    buffer_load_dwordx4 v[20:23], v252, s[52:55], s19 offen offset:1024 sc1
    v_mfma_f32_16x16x32_bf16 v[72:75], v[192:195], v[32:35], v[72:75]
    buffer_load_dwordx4 v[24:27], v252, s[52:55], s20 offen offset:1024 sc1
    v_mfma_f32_16x16x32_bf16 v[76:79], v[196:199], v[32:35], v[76:79]
    buffer_load_dwordx4 v[28:31], v252, s[52:55], s21 offen offset:1024 sc1
    v_mfma_f32_16x16x32_bf16 v[80:83], v[200:203], v[32:35], v[80:83]
    ds_read_b128 v[164:167], v1 offset:0
    v_mfma_f32_16x16x32_bf16 v[84:87], v[184:187], v[36:39], v[84:87]
    ds_read_b128 v[168:171], v1 offset:1024
    v_mfma_f32_16x16x32_bf16 v[88:91], v[188:191], v[36:39], v[88:91]
    ds_read_b128 v[172:175], v1 offset:2048
    v_mfma_f32_16x16x32_bf16 v[92:95], v[192:195], v[36:39], v[92:95]
    ds_read_b128 v[176:179], v1 offset:3072
    v_mfma_f32_16x16x32_bf16 v[96:99], v[196:199], v[36:39], v[96:99]
    ds_read_b128 v[180:183], v1 offset:4096
    v_mfma_f32_16x16x32_bf16 v[100:103], v[200:203], v[36:39], v[100:103]
    v_mfma_f32_16x16x32_bf16 v[104:107], v[184:187], v[40:43], v[104:107]
    v_mfma_f32_16x16x32_bf16 v[108:111], v[188:191], v[40:43], v[108:111]
    v_mfma_f32_16x16x32_bf16 v[112:115], v[192:195], v[40:43], v[112:115]
    v_mfma_f32_16x16x32_bf16 v[116:119], v[196:199], v[40:43], v[116:119]
    v_mfma_f32_16x16x32_bf16 v[120:123], v[200:203], v[40:43], v[120:123]
    v_mfma_f32_16x16x32_bf16 v[124:127], v[184:187], v[44:47], v[124:127]
    v_mfma_f32_16x16x32_bf16 v[128:131], v[188:191], v[44:47], v[128:131]
    v_mfma_f32_16x16x32_bf16 v[132:135], v[192:195], v[44:47], v[132:135]
    v_mfma_f32_16x16x32_bf16 v[136:139], v[196:199], v[44:47], v[136:139]
    v_mfma_f32_16x16x32_bf16 v[140:143], v[200:203], v[44:47], v[140:143]
    s_waitcnt vmcnt(13)
    s_cmp_eq_u32 s4, 0
    s_cbranch_scc1 L_g_skip6
    v_mfma_f32_16x16x32_bf16 v[64:67], v[204:207], v[48:51], v[64:67]
    buffer_load_dwordx4 v[32:35], v252, s[52:55], s18 offen offset:2048 sc1
    v_mfma_f32_16x16x32_bf16 v[68:71], v[208:211], v[48:51], v[68:71]
    buffer_load_dwordx4 v[36:39], v252, s[52:55], s19 offen offset:2048 sc1
    v_mfma_f32_16x16x32_bf16 v[72:75], v[212:215], v[48:51], v[72:75]
    buffer_load_dwordx4 v[40:43], v252, s[52:55], s20 offen offset:2048 sc1
    v_mfma_f32_16x16x32_bf16 v[76:79], v[216:219], v[48:51], v[76:79]
    buffer_load_dwordx4 v[44:47], v252, s[52:55], s21 offen offset:2048 sc1
    v_mfma_f32_16x16x32_bf16 v[80:83], v[220:223], v[48:51], v[80:83]
    buffer_load_dwordx4 v[184:187], v252, s[52:55], s22 offen offset:2048 sc1
    v_mfma_f32_16x16x32_bf16 v[84:87], v[204:207], v[52:55], v[84:87]
    buffer_load_dwordx4 v[188:191], v252, s[52:55], s23 offen offset:2048 sc1
    v_mfma_f32_16x16x32_bf16 v[88:91], v[208:211], v[52:55], v[88:91]
    buffer_load_dwordx4 v[192:195], v252, s[52:55], s24 offen offset:2048 sc1
    v_mfma_f32_16x16x32_bf16 v[92:95], v[212:215], v[52:55], v[92:95]
    buffer_load_dwordx4 v[196:199], v252, s[52:55], s25 offen offset:2048 sc1
    v_mfma_f32_16x16x32_bf16 v[96:99], v[216:219], v[52:55], v[96:99]
    buffer_load_dwordx4 v[200:203], v252, s[52:55], s26 offen offset:2048 sc1
    v_mfma_f32_16x16x32_bf16 v[100:103], v[220:223], v[52:55], v[100:103]
    v_mfma_f32_16x16x32_bf16 v[104:107], v[204:207], v[56:59], v[104:107]
    v_mfma_f32_16x16x32_bf16 v[108:111], v[208:211], v[56:59], v[108:111]
    v_mfma_f32_16x16x32_bf16 v[112:115], v[212:215], v[56:59], v[112:115]
    v_mfma_f32_16x16x32_bf16 v[116:119], v[216:219], v[56:59], v[116:119]
    v_mfma_f32_16x16x32_bf16 v[120:123], v[220:223], v[56:59], v[120:123]
    v_mfma_f32_16x16x32_bf16 v[124:127], v[204:207], v[60:63], v[124:127]
    v_mfma_f32_16x16x32_bf16 v[128:131], v[208:211], v[60:63], v[128:131]
    v_mfma_f32_16x16x32_bf16 v[132:135], v[212:215], v[60:63], v[132:135]
    v_mfma_f32_16x16x32_bf16 v[136:139], v[216:219], v[60:63], v[136:139]
    v_mfma_f32_16x16x32_bf16 v[140:143], v[220:223], v[60:63], v[140:143]
    s_branch L_g_join6
L_g_skip6:
    s_nop 7
    buffer_load_dwordx4 v[32:35], v252, s[52:55], s18 offen offset:2048 sc1
    buffer_load_dwordx4 v[36:39], v252, s[52:55], s19 offen offset:2048 sc1
    buffer_load_dwordx4 v[40:43], v252, s[52:55], s20 offen offset:2048 sc1
    buffer_load_dwordx4 v[44:47], v252, s[52:55], s21 offen offset:2048 sc1
    buffer_load_dwordx4 v[184:187], v252, s[52:55], s22 offen offset:2048 sc1
    buffer_load_dwordx4 v[188:191], v252, s[52:55], s23 offen offset:2048 sc1
    buffer_load_dwordx4 v[192:195], v252, s[52:55], s24 offen offset:2048 sc1
    buffer_load_dwordx4 v[196:199], v252, s[52:55], s25 offen offset:2048 sc1
    buffer_load_dwordx4 v[200:203], v252, s[52:55], s26 offen offset:2048 sc1
L_g_join6:
    s_waitcnt vmcnt(13)
    v_mfma_f32_16x16x32_bf16 v[64:67], v[144:147], v[224:227], v[64:67]
    buffer_load_dwordx4 v[48:51], v252, s[52:55], s18 offen offset:3072 sc1
    v_mfma_f32_16x16x32_bf16 v[68:71], v[148:151], v[224:227], v[68:71]
    buffer_load_dwordx4 v[52:55], v252, s[52:55], s19 offen offset:3072 sc1
    v_mfma_f32_16x16x32_bf16 v[72:75], v[152:155], v[224:227], v[72:75]
    buffer_load_dwordx4 v[56:59], v252, s[52:55], s20 offen offset:3072 sc1
    v_mfma_f32_16x16x32_bf16 v[76:79], v[156:159], v[224:227], v[76:79]
    buffer_load_dwordx4 v[60:63], v252, s[52:55], s21 offen offset:3072 sc1
    v_mfma_f32_16x16x32_bf16 v[80:83], v[160:163], v[224:227], v[80:83]
    ds_read_b128 v[204:207], v1 offset:5120
    v_mfma_f32_16x16x32_bf16 v[84:87], v[144:147], v[228:231], v[84:87]
    ds_read_b128 v[208:211], v1 offset:6144
    v_mfma_f32_16x16x32_bf16 v[88:91], v[148:151], v[228:231], v[88:91]
    ds_read_b128 v[212:215], v1 offset:7168
    v_mfma_f32_16x16x32_bf16 v[92:95], v[152:155], v[228:231], v[92:95]
    ds_read_b128 v[216:219], v1 offset:8192
    v_mfma_f32_16x16x32_bf16 v[96:99], v[156:159], v[228:231], v[96:99]
    ds_read_b128 v[220:223], v1 offset:9216
    v_mfma_f32_16x16x32_bf16 v[100:103], v[160:163], v[228:231], v[100:103]
    v_mfma_f32_16x16x32_bf16 v[104:107], v[144:147], v[232:235], v[104:107]
    v_mfma_f32_16x16x32_bf16 v[108:111], v[148:151], v[232:235], v[108:111]
    v_mfma_f32_16x16x32_bf16 v[112:115], v[152:155], v[232:235], v[112:115]
    v_mfma_f32_16x16x32_bf16 v[116:119], v[156:159], v[232:235], v[116:119]
    v_mfma_f32_16x16x32_bf16 v[120:123], v[160:163], v[232:235], v[120:123]
    v_mfma_f32_16x16x32_bf16 v[124:127], v[144:147], v[236:239], v[124:127]
    v_mfma_f32_16x16x32_bf16 v[128:131], v[148:151], v[236:239], v[128:131]
    v_mfma_f32_16x16x32_bf16 v[132:135], v[152:155], v[236:239], v[132:135]
    v_mfma_f32_16x16x32_bf16 v[136:139], v[156:159], v[236:239], v[136:139]
    v_mfma_f32_16x16x32_bf16 v[140:143], v[160:163], v[236:239], v[140:143]
    s_add_u32 s18, s18, 4096
    s_add_u32 s19, s19, 4096
    s_add_u32 s20, s20, 4096
    s_add_u32 s21, s21, 4096
    s_add_u32 s22, s22, 4096
    s_add_u32 s23, s23, 4096
    s_add_u32 s24, s24, 4096
    s_add_u32 s25, s25, 4096
    s_add_u32 s26, s26, 4096
    s_waitcnt vmcnt(13) lgkmcnt(0)
    v_mfma_f32_16x16x32_bf16 v[64:67], v[164:167], v[16:19], v[64:67]
    buffer_load_dwordx4 v[224:227], v252, s[52:55], s18 offen offset:0 sc1
    v_mfma_f32_16x16x32_bf16 v[68:71], v[168:171], v[16:19], v[68:71]
    buffer_load_dwordx4 v[228:231], v252, s[52:55], s19 offen offset:0 sc1
    v_mfma_f32_16x16x32_bf16 v[72:75], v[172:175], v[16:19], v[72:75]
    buffer_load_dwordx4 v[232:235], v252, s[52:55], s20 offen offset:0 sc1
    v_mfma_f32_16x16x32_bf16 v[76:79], v[176:179], v[16:19], v[76:79]
    buffer_load_dwordx4 v[236:239], v252, s[52:55], s21 offen offset:0 sc1
    v_mfma_f32_16x16x32_bf16 v[80:83], v[180:183], v[16:19], v[80:83]
    buffer_load_dwordx4 v[144:147], v252, s[52:55], s22 offen offset:0 sc1
    v_mfma_f32_16x16x32_bf16 v[84:87], v[164:167], v[20:23], v[84:87]
    buffer_load_dwordx4 v[148:151], v252, s[52:55], s23 offen offset:0 sc1
    v_mfma_f32_16x16x32_bf16 v[88:91], v[168:171], v[20:23], v[88:91]
    buffer_load_dwordx4 v[152:155], v252, s[52:55], s24 offen offset:0 sc1
    v_mfma_f32_16x16x32_bf16 v[92:95], v[172:175], v[20:23], v[92:95]
    buffer_load_dwordx4 v[156:159], v252, s[52:55], s25 offen offset:0 sc1
    v_mfma_f32_16x16x32_bf16 v[96:99], v[176:179], v[20:23], v[96:99]
    buffer_load_dwordx4 v[160:163], v252, s[52:55], s26 offen offset:0 sc1
    v_mfma_f32_16x16x32_bf16 v[100:103], v[180:183], v[20:23], v[100:103]
    v_mfma_f32_16x16x32_bf16 v[104:107], v[164:167], v[24:27], v[104:107]
    v_mfma_f32_16x16x32_bf16 v[108:111], v[168:171], v[24:27], v[108:111]
    v_mfma_f32_16x16x32_bf16 v[112:115], v[172:175], v[24:27], v[112:115]
    v_mfma_f32_16x16x32_bf16 v[116:119], v[176:179], v[24:27], v[116:119]
    v_mfma_f32_16x16x32_bf16 v[120:123], v[180:183], v[24:27], v[120:123]
    v_mfma_f32_16x16x32_bf16 v[124:127], v[164:167], v[28:31], v[124:127]
    v_mfma_f32_16x16x32_bf16 v[128:131], v[168:171], v[28:31], v[128:131]
    v_mfma_f32_16x16x32_bf16 v[132:135], v[172:175], v[28:31], v[132:135]
    v_mfma_f32_16x16x32_bf16 v[136:139], v[176:179], v[28:31], v[136:139]
    v_mfma_f32_16x16x32_bf16 v[140:143], v[180:183], v[28:31], v[140:143]
    s_waitcnt vmcnt(13)
    v_mfma_f32_16x16x32_bf16 v[64:67], v[184:187], v[32:35], v[64:67]
    buffer_load_dwordx4 v[16:19], v252, s[52:55], s18 offen offset:1024 sc1
    v_mfma_f32_16x16x32_bf16 v[68:71], v[188:191], v[32:35], v[68:71]
    buffer_load_dwordx4 v[20:23], v252, s[52:55], s19 offen offset:1024 sc1
    v_mfma_f32_16x16x32_bf16 v[72:75], v[192:195], v[32:35], v[72:75]
    buffer_load_dwordx4 v[24:27], v252, s[52:55], s20 offen offset:1024 sc1
    v_mfma_f32_16x16x32_bf16 v[76:79], v[196:199], v[32:35], v[76:79]
    buffer_load_dwordx4 v[28:31], v252, s[52:55], s21 offen offset:1024 sc1
    v_mfma_f32_16x16x32_bf16 v[80:83], v[200:203], v[32:35], v[80:83]
    ds_read_b128 v[164:167], v1 offset:10240
    v_mfma_f32_16x16x32_bf16 v[84:87], v[184:187], v[36:39], v[84:87]
    ds_read_b128 v[168:171], v1 offset:11264
    v_mfma_f32_16x16x32_bf16 v[88:91], v[188:191], v[36:39], v[88:91]
    ds_read_b128 v[172:175], v1 offset:12288
    v_mfma_f32_16x16x32_bf16 v[92:95], v[192:195], v[36:39], v[92:95]
    ds_read_b128 v[176:179], v1 offset:13312
    v_mfma_f32_16x16x32_bf16 v[96:99], v[196:199], v[36:39], v[96:99]
    ds_read_b128 v[180:183], v1 offset:14336
    v_mfma_f32_16x16x32_bf16 v[100:103], v[200:203], v[36:39], v[100:103]
    v_mfma_f32_16x16x32_bf16 v[104:107], v[184:187], v[40:43], v[104:107]
    v_mfma_f32_16x16x32_bf16 v[108:111], v[188:191], v[40:43], v[108:111]
    v_mfma_f32_16x16x32_bf16 v[112:115], v[192:195], v[40:43], v[112:115]
    v_mfma_f32_16x16x32_bf16 v[116:119], v[196:199], v[40:43], v[116:119]
    v_mfma_f32_16x16x32_bf16 v[120:123], v[200:203], v[40:43], v[120:123]
    v_mfma_f32_16x16x32_bf16 v[124:127], v[184:187], v[44:47], v[124:127]
    v_mfma_f32_16x16x32_bf16 v[128:131], v[188:191], v[44:47], v[128:131]
    v_mfma_f32_16x16x32_bf16 v[132:135], v[192:195], v[44:47], v[132:135]
    v_mfma_f32_16x16x32_bf16 v[136:139], v[196:199], v[44:47], v[136:139]
    v_mfma_f32_16x16x32_bf16 v[140:143], v[200:203], v[44:47], v[140:143]
    s_waitcnt vmcnt(13) lgkmcnt(0)
    v_mfma_f32_16x16x32_bf16 v[64:67], v[204:207], v[48:51], v[64:67]
    buffer_load_dwordx4 v[32:35], v253, s[52:55], s18 offen offset:2048 sc1
    v_mfma_f32_16x16x32_bf16 v[68:71], v[208:211], v[48:51], v[68:71]
    buffer_load_dwordx4 v[36:39], v253, s[52:55], s19 offen offset:2048 sc1
    v_mfma_f32_16x16x32_bf16 v[72:75], v[212:215], v[48:51], v[72:75]
    buffer_load_dwordx4 v[40:43], v253, s[52:55], s20 offen offset:2048 sc1
    v_mfma_f32_16x16x32_bf16 v[76:79], v[216:219], v[48:51], v[76:79]
    buffer_load_dwordx4 v[44:47], v253, s[52:55], s21 offen offset:2048 sc1
    v_mfma_f32_16x16x32_bf16 v[80:83], v[220:223], v[48:51], v[80:83]
    buffer_load_dwordx4 v[184:187], v253, s[52:55], s22 offen offset:2048 sc1
    v_mfma_f32_16x16x32_bf16 v[84:87], v[204:207], v[52:55], v[84:87]
    buffer_load_dwordx4 v[188:191], v253, s[52:55], s23 offen offset:2048 sc1
    v_mfma_f32_16x16x32_bf16 v[88:91], v[208:211], v[52:55], v[88:91]
    buffer_load_dwordx4 v[192:195], v253, s[52:55], s24 offen offset:2048 sc1
    v_mfma_f32_16x16x32_bf16 v[92:95], v[212:215], v[52:55], v[92:95]
    buffer_load_dwordx4 v[196:199], v253, s[52:55], s25 offen offset:2048 sc1
    v_mfma_f32_16x16x32_bf16 v[96:99], v[216:219], v[52:55], v[96:99]
    buffer_load_dwordx4 v[200:203], v253, s[52:55], s26 offen offset:2048 sc1
    v_mfma_f32_16x16x32_bf16 v[100:103], v[220:223], v[52:55], v[100:103]
    v_mfma_f32_16x16x32_bf16 v[104:107], v[204:207], v[56:59], v[104:107]
    v_mfma_f32_16x16x32_bf16 v[108:111], v[208:211], v[56:59], v[108:111]
    v_mfma_f32_16x16x32_bf16 v[112:115], v[212:215], v[56:59], v[112:115]
    v_mfma_f32_16x16x32_bf16 v[116:119], v[216:219], v[56:59], v[116:119]
    v_mfma_f32_16x16x32_bf16 v[120:123], v[220:223], v[56:59], v[120:123]
    v_mfma_f32_16x16x32_bf16 v[124:127], v[204:207], v[60:63], v[124:127]
    v_mfma_f32_16x16x32_bf16 v[128:131], v[208:211], v[60:63], v[128:131]
    v_mfma_f32_16x16x32_bf16 v[132:135], v[212:215], v[60:63], v[132:135]
    v_mfma_f32_16x16x32_bf16 v[136:139], v[216:219], v[60:63], v[136:139]
    v_mfma_f32_16x16x32_bf16 v[140:143], v[220:223], v[60:63], v[140:143]
    s_waitcnt vmcnt(13)
    v_mfma_f32_16x16x32_bf16 v[64:67], v[144:147], v[224:227], v[64:67]
    v_mfma_f32_16x16x32_bf16 v[68:71], v[148:151], v[224:227], v[68:71]
    v_mfma_f32_16x16x32_bf16 v[72:75], v[152:155], v[224:227], v[72:75]
    v_mfma_f32_16x16x32_bf16 v[76:79], v[156:159], v[224:227], v[76:79]
    v_mfma_f32_16x16x32_bf16 v[80:83], v[160:163], v[224:227], v[80:83]
    v_mfma_f32_16x16x32_bf16 v[84:87], v[144:147], v[228:231], v[84:87]
    v_mfma_f32_16x16x32_bf16 v[88:91], v[148:151], v[228:231], v[88:91]
    v_mfma_f32_16x16x32_bf16 v[92:95], v[152:155], v[228:231], v[92:95]
    v_mfma_f32_16x16x32_bf16 v[96:99], v[156:159], v[228:231], v[96:99]
    v_mfma_f32_16x16x32_bf16 v[100:103], v[160:163], v[228:231], v[100:103]
    v_mfma_f32_16x16x32_bf16 v[104:107], v[144:147], v[232:235], v[104:107]
    v_mfma_f32_16x16x32_bf16 v[108:111], v[148:151], v[232:235], v[108:111]
    v_mfma_f32_16x16x32_bf16 v[112:115], v[152:155], v[232:235], v[112:115]
    v_mfma_f32_16x16x32_bf16 v[116:119], v[156:159], v[232:235], v[116:119]
    v_mfma_f32_16x16x32_bf16 v[120:123], v[160:163], v[232:235], v[120:123]
    v_mfma_f32_16x16x32_bf16 v[124:127], v[144:147], v[236:239], v[124:127]
    v_mfma_f32_16x16x32_bf16 v[128:131], v[148:151], v[236:239], v[128:131]
    v_mfma_f32_16x16x32_bf16 v[132:135], v[152:155], v[236:239], v[132:135]
    v_mfma_f32_16x16x32_bf16 v[136:139], v[156:159], v[236:239], v[136:139]
    v_mfma_f32_16x16x32_bf16 v[140:143], v[160:163], v[236:239], v[140:143]
    s_waitcnt vmcnt(9) lgkmcnt(0)
    v_mfma_f32_16x16x32_bf16 v[64:67], v[164:167], v[16:19], v[64:67]
    v_mfma_f32_16x16x32_bf16 v[68:71], v[168:171], v[16:19], v[68:71]
    v_mfma_f32_16x16x32_bf16 v[72:75], v[172:175], v[16:19], v[72:75]
    v_mfma_f32_16x16x32_bf16 v[76:79], v[176:179], v[16:19], v[76:79]
    v_mfma_f32_16x16x32_bf16 v[80:83], v[180:183], v[16:19], v[80:83]
    v_mfma_f32_16x16x32_bf16 v[84:87], v[164:167], v[20:23], v[84:87]
    v_mfma_f32_16x16x32_bf16 v[88:91], v[168:171], v[20:23], v[88:91]
    v_mfma_f32_16x16x32_bf16 v[92:95], v[172:175], v[20:23], v[92:95]
    v_mfma_f32_16x16x32_bf16 v[96:99], v[176:179], v[20:23], v[96:99]
    v_mfma_f32_16x16x32_bf16 v[100:103], v[180:183], v[20:23], v[100:103]
    v_mfma_f32_16x16x32_bf16 v[104:107], v[164:167], v[24:27], v[104:107]
    v_mfma_f32_16x16x32_bf16 v[108:111], v[168:171], v[24:27], v[108:111]
    v_mfma_f32_16x16x32_bf16 v[112:115], v[172:175], v[24:27], v[112:115]
    v_mfma_f32_16x16x32_bf16 v[116:119], v[176:179], v[24:27], v[116:119]
    v_mfma_f32_16x16x32_bf16 v[120:123], v[180:183], v[24:27], v[120:123]
    v_mfma_f32_16x16x32_bf16 v[124:127], v[164:167], v[28:31], v[124:127]
    v_mfma_f32_16x16x32_bf16 v[128:131], v[168:171], v[28:31], v[128:131]
    v_mfma_f32_16x16x32_bf16 v[132:135], v[172:175], v[28:31], v[132:135]
    v_mfma_f32_16x16x32_bf16 v[136:139], v[176:179], v[28:31], v[136:139]
    v_mfma_f32_16x16x32_bf16 v[140:143], v[180:183], v[28:31], v[140:143]
    s_waitcnt vmcnt(0)
    s_cmp_eq_u32 s4, 0
    s_cbranch_scc1 L_g_skip13
    v_mfma_f32_16x16x32_bf16 v[84:87], v[184:187], v[36:39], v[84:87]
    v_mfma_f32_16x16x32_bf16 v[88:91], v[188:191], v[36:39], v[88:91]
    v_mfma_f32_16x16x32_bf16 v[92:95], v[192:195], v[36:39], v[92:95]
    v_mfma_f32_16x16x32_bf16 v[96:99], v[196:199], v[36:39], v[96:99]
    v_mfma_f32_16x16x32_bf16 v[100:103], v[200:203], v[36:39], v[100:103]
    v_mfma_f32_16x16x32_bf16 v[104:107], v[184:187], v[40:43], v[104:107]
    s_nop 2
    ds_write_b128 v1, v[84:87] offset:0
    v_mfma_f32_16x16x32_bf16 v[108:111], v[188:191], v[40:43], v[108:111]
    ds_write_b128 v1, v[88:91] offset:1024
    v_mfma_f32_16x16x32_bf16 v[112:115], v[192:195], v[40:43], v[112:115]
    ds_write_b128 v1, v[92:95] offset:2048
    v_mfma_f32_16x16x32_bf16 v[116:119], v[196:199], v[40:43], v[116:119]
    ds_write_b128 v1, v[96:99] offset:3072
    v_mfma_f32_16x16x32_bf16 v[120:123], v[200:203], v[40:43], v[120:123]
    ds_write_b128 v1, v[100:103] offset:4096
    v_mfma_f32_16x16x32_bf16 v[124:127], v[184:187], v[44:47], v[124:127]
    ds_write_b128 v1, v[104:107] offset:5120
    v_mfma_f32_16x16x32_bf16 v[128:131], v[188:191], v[44:47], v[128:131]
    ds_write_b128 v1, v[108:111] offset:6144
    v_mfma_f32_16x16x32_bf16 v[132:135], v[192:195], v[44:47], v[132:135]
    ds_write_b128 v1, v[112:115] offset:7168
    v_mfma_f32_16x16x32_bf16 v[136:139], v[196:199], v[44:47], v[136:139]
    ds_write_b128 v1, v[116:119] offset:8192
    v_mfma_f32_16x16x32_bf16 v[140:143], v[200:203], v[44:47], v[140:143]
    ds_write_b128 v1, v[120:123] offset:9216
    v_mfma_f32_16x16x32_bf16 v[64:67], v[184:187], v[32:35], v[64:67]
    ds_write_b128 v1, v[124:127] offset:10240
    v_mfma_f32_16x16x32_bf16 v[68:71], v[188:191], v[32:35], v[68:71]
    ds_write_b128 v1, v[128:131] offset:11264
    v_mfma_f32_16x16x32_bf16 v[72:75], v[192:195], v[32:35], v[72:75]
    ds_write_b128 v1, v[132:135] offset:12288
    v_mfma_f32_16x16x32_bf16 v[76:79], v[196:199], v[32:35], v[76:79]
    ds_write_b128 v1, v[136:139] offset:13312
    v_mfma_f32_16x16x32_bf16 v[80:83], v[200:203], v[32:35], v[80:83]
    ds_write_b128 v1, v[140:143] offset:14336
    s_branch L_g_join13
L_g_skip13:
    s_nop 7
    ds_write_b128 v1, v[84:87] offset:0
    ds_write_b128 v1, v[88:91] offset:1024
    ds_write_b128 v1, v[92:95] offset:2048
    ds_write_b128 v1, v[96:99] offset:3072
    ds_write_b128 v1, v[100:103] offset:4096
    ds_write_b128 v1, v[104:107] offset:5120
    ds_write_b128 v1, v[108:111] offset:6144
    ds_write_b128 v1, v[112:115] offset:7168
    ds_write_b128 v1, v[116:119] offset:8192
    ds_write_b128 v1, v[120:123] offset:9216
    ds_write_b128 v1, v[124:127] offset:10240
    ds_write_b128 v1, v[128:131] offset:11264
    ds_write_b128 v1, v[132:135] offset:12288
    ds_write_b128 v1, v[136:139] offset:13312
    ds_write_b128 v1, v[140:143] offset:14336
L_g_join13:
    s_waitcnt lgkmcnt(0)
    s_barrier
    ds_read_b128 v[144:147], v2 offset:0
    ds_read_b128 v[148:151], v2 offset:1024
    ds_read_b128 v[152:155], v2 offset:2048
    ds_read_b128 v[156:159], v2 offset:3072
    ds_read_b128 v[160:163], v2 offset:4096
    ds_read_b128 v[164:167], v3 offset:0
    ds_read_b128 v[168:171], v3 offset:1024
    ds_read_b128 v[172:175], v3 offset:2048
    ds_read_b128 v[176:179], v3 offset:3072
    ds_read_b128 v[180:183], v3 offset:4096
    ds_read_b64_tr_b16 v[16:17], v5 offset:0
    ds_read_b64_tr_b16 v[18:19], v5 offset:2048
    ds_read_b64_tr_b16 v[20:21], v5 offset:4096
    ds_read_b64_tr_b16 v[22:23], v5 offset:6144
    ds_read_b64_tr_b16 v[24:25], v5 offset:8192
    s_waitcnt lgkmcnt(14)
    v_pk_add_f32 v[64:65], v[64:65], v[144:145]
    v_pk_add_f32 v[66:67], v[66:67], v[146:147]
    ds_read_b128 v[184:187], v4 offset:0
    s_waitcnt lgkmcnt(14)
    v_pk_add_f32 v[68:69], v[68:69], v[148:149]
    v_pk_add_f32 v[70:71], v[70:71], v[150:151]
    ds_read_b128 v[188:191], v4 offset:1024
    s_waitcnt lgkmcnt(14)
    v_pk_add_f32 v[72:73], v[72:73], v[152:153]
    v_pk_add_f32 v[74:75], v[74:75], v[154:155]
    ds_read_b128 v[192:195], v4 offset:2048
    s_waitcnt lgkmcnt(14)
    v_pk_add_f32 v[76:77], v[76:77], v[156:157]
    v_pk_add_f32 v[78:79], v[78:79], v[158:159]
    ds_read_b128 v[196:199], v4 offset:3072
    s_waitcnt lgkmcnt(14)
    v_pk_add_f32 v[80:81], v[80:81], v[160:161]
    v_pk_add_f32 v[82:83], v[82:83], v[162:163]
    ds_read_b128 v[200:203], v4 offset:4096
    s_waitcnt lgkmcnt(14)
    v_pk_add_f32 v[64:65], v[64:65], v[164:165]
    v_pk_add_f32 v[66:67], v[66:67], v[166:167]
    s_waitcnt lgkmcnt(13)
    v_pk_add_f32 v[68:69], v[68:69], v[168:169]
    v_pk_add_f32 v[70:71], v[70:71], v[170:171]
    s_waitcnt lgkmcnt(12)
    v_pk_add_f32 v[72:73], v[72:73], v[172:173]
    v_pk_add_f32 v[74:75], v[74:75], v[174:175]
    s_waitcnt lgkmcnt(11)
    v_pk_add_f32 v[76:77], v[76:77], v[176:177]
    v_pk_add_f32 v[78:79], v[78:79], v[178:179]
    s_waitcnt lgkmcnt(10)
    v_pk_add_f32 v[80:81], v[80:81], v[180:181]
    v_pk_add_f32 v[82:83], v[82:83], v[182:183]
    s_waitcnt lgkmcnt(9)
    v_lshlrev_b32 v10, 16, v16
    v_and_b32 v11, 0xffff0000, v16
    v_pk_add_f32 v[64:65], v[64:65], v[10:11]
    v_lshlrev_b32 v10, 16, v17
    v_and_b32 v11, 0xffff0000, v17
    v_pk_add_f32 v[66:67], v[66:67], v[10:11]
    s_waitcnt lgkmcnt(8)
    v_lshlrev_b32 v10, 16, v18
    v_and_b32 v11, 0xffff0000, v18
    v_pk_add_f32 v[68:69], v[68:69], v[10:11]
    v_lshlrev_b32 v10, 16, v19
    v_and_b32 v11, 0xffff0000, v19
    v_pk_add_f32 v[70:71], v[70:71], v[10:11]
    s_waitcnt lgkmcnt(7)
    v_lshlrev_b32 v10, 16, v20
    v_and_b32 v11, 0xffff0000, v20
    v_pk_add_f32 v[72:73], v[72:73], v[10:11]
    v_lshlrev_b32 v10, 16, v21
    v_and_b32 v11, 0xffff0000, v21
    v_pk_add_f32 v[74:75], v[74:75], v[10:11]
    s_waitcnt lgkmcnt(6)
    v_lshlrev_b32 v10, 16, v22
    v_and_b32 v11, 0xffff0000, v22
    v_pk_add_f32 v[76:77], v[76:77], v[10:11]
    v_lshlrev_b32 v10, 16, v23
    v_and_b32 v11, 0xffff0000, v23
    v_pk_add_f32 v[78:79], v[78:79], v[10:11]
    s_waitcnt lgkmcnt(5)
    v_lshlrev_b32 v10, 16, v24
    v_and_b32 v11, 0xffff0000, v24
    v_pk_add_f32 v[80:81], v[80:81], v[10:11]
    v_lshlrev_b32 v10, 16, v25
    v_and_b32 v11, 0xffff0000, v25
    v_pk_add_f32 v[82:83], v[82:83], v[10:11]
    s_waitcnt lgkmcnt(0)
    v_pk_add_f32 v[64:65], v[64:65], v[184:185]
    v_pk_add_f32 v[66:67], v[66:67], v[186:187]
    v_cvt_pk_bf16_f32 v32, v64, v65
    v_cvt_pk_bf16_f32 v33, v66, v67
    ds_write_b64 v6, v[32:33] offset:0
    v_pk_add_f32 v[68:69], v[68:69], v[188:189]
    v_pk_add_f32 v[70:71], v[70:71], v[190:191]
    v_cvt_pk_bf16_f32 v34, v68, v69
    v_cvt_pk_bf16_f32 v35, v70, v71
    ds_write_b64 v6, v[34:35] offset:32
    v_pk_add_f32 v[72:73], v[72:73], v[192:193]
    v_pk_add_f32 v[74:75], v[74:75], v[194:195]
    v_cvt_pk_bf16_f32 v36, v72, v73
    v_cvt_pk_bf16_f32 v37, v74, v75
    ds_write_b64 v6, v[36:37] offset:64
    v_pk_add_f32 v[76:77], v[76:77], v[196:197]
    v_pk_add_f32 v[78:79], v[78:79], v[198:199]
    v_cvt_pk_bf16_f32 v38, v76, v77
    v_cvt_pk_bf16_f32 v39, v78, v79
    ds_write_b64 v6, v[38:39] offset:96
    v_pk_add_f32 v[80:81], v[80:81], v[200:201]
    v_pk_add_f32 v[82:83], v[82:83], v[202:203]
    v_cvt_pk_bf16_f32 v40, v80, v81
    v_cvt_pk_bf16_f32 v41, v82, v83
    ds_write_b64 v6, v[40:41] offset:128
    ds_read_b128 v[48:51], v7 offset:0
    ds_read_b128 v[52:55], v7 offset:1024
    ds_read_b128 v[56:59], v7 offset:2048
    s_waitcnt lgkmcnt(2)
    buffer_store_dwordx4 v[48:51], v8, s[56:59], s27 offen
    s_waitcnt lgkmcnt(1)
    buffer_store_dwordx4 v[52:55], v9, s[56:59], s27 offen
    s_waitcnt lgkmcnt(0)
    buffer_store_dwordx4 v[56:59], v13, s[56:59], s27 offen
    s_branch L_end
L_park:
    s_lshl_b32 s12, s5, 3
    s_lshr_b32 s9, s7, 2
    s_add_u32 s12, s12, s9
    s_lshl_b32 s9, s6, 2
    s_and_b32 s10, s7, 3
    s_add_u32 s9, s9, s10
    v_add_u32 v2, 55296, v1
    v_add_u32 v3, 110592, v1
    v_add_u32 v4, 165888, v1
    v_add_u32 v5, 221184, v1
    s_mul_i32 s12, s9, 276480
    s_add_u32 s12, s12, 7864320
    s_mov_b32 s10, 0
    s_mov_b32 s3, 0
    s_load_dword s26, s[48:49], s25 glc
L_spoll_12:
    s_waitcnt lgkmcnt(0)
    s_cmp_lg_u32 s26, 0
    s_cbranch_scc1 L_sdone_13
    s_add_u32 s50, s50, 1
    s_cmp_gt_u32 s50, 100000
    s_cbranch_scc1 L_exit
    s_sleep 10
    s_load_dword s26, s[48:49], s25 glc
    s_branch L_spoll_12
L_sdone_13:
L_pk_loop:
    s_add_u32 s13, s12, 28672
    s_add_u32 m0, s10, 0
    s_nop 0
    buffer_load_dwordx4 v1, s[52:55], s13 offen sc1 lds
    s_add_u32 m0, s10, 1024
    s_nop 0
    buffer_load_dwordx4 v2, s[52:55], s13 offen sc1 lds
    s_add_u32 m0, s10, 2048
    s_nop 0
    buffer_load_dwordx4 v3, s[52:55], s13 offen sc1 lds
    s_add_u32 m0, s10, 3072
    s_nop 0
    buffer_load_dwordx4 v4, s[52:55], s13 offen sc1 lds
    s_add_u32 m0, s10, 4096
    s_nop 0
    buffer_load_dwordx4 v5, s[52:55], s13 offen sc1 lds
    s_waitcnt vmcnt(15)
    s_add_u32 s13, s12, 30720
    s_add_u32 m0, s10, 5120
    s_nop 0
    buffer_load_dwordx4 v1, s[52:55], s13 offen sc1 lds
    s_add_u32 m0, s10, 6144
    s_nop 0
    buffer_load_dwordx4 v2, s[52:55], s13 offen sc1 lds
    s_add_u32 m0, s10, 7168
    s_nop 0
    buffer_load_dwordx4 v3, s[52:55], s13 offen sc1 lds
    s_add_u32 m0, s10, 8192
    s_nop 0
    buffer_load_dwordx4 v4, s[52:55], s13 offen sc1 lds
    s_add_u32 m0, s10, 9216
    s_nop 0
    buffer_load_dwordx4 v5, s[52:55], s13 offen sc1 lds
    s_waitcnt vmcnt(15)
    s_add_u32 s13, s12, 32768
    s_add_u32 m0, s10, 10240
    s_nop 0
    buffer_load_dwordx4 v1, s[52:55], s13 offen sc1 lds
    s_add_u32 m0, s10, 11264
    s_nop 0
    buffer_load_dwordx4 v2, s[52:55], s13 offen sc1 lds
    s_add_u32 m0, s10, 12288
    s_nop 0
    buffer_load_dwordx4 v3, s[52:55], s13 offen sc1 lds
    s_add_u32 m0, s10, 13312
    s_nop 0
    buffer_load_dwordx4 v4, s[52:55], s13 offen sc1 lds
    s_add_u32 m0, s10, 14336
    s_nop 0
    buffer_load_dwordx4 v5, s[52:55], s13 offen sc1 lds
    s_waitcnt vmcnt(15)
    s_cmp_eq_u32 s3, 0
    s_cselect_b32 s13, 6, 7
    s_lshl_b32 s13, s13, 10
    s_add_u32 s12, s12, s13
    s_add_u32 s10, s10, 20480
    s_add_u32 s3, s3, 1
    s_cmp_lt_u32 s3, 4
    s_cbranch_scc1 L_pk_loop
    v_mov_b32 v2, 163456
    v_mov_b32 v3, 1
    s_waitcnt vmcnt(0)
    ds_write_b32 v2, v3
    s_waitcnt lgkmcnt(0)
    s_branch L_end
L_fetch:
    s_lshl_b32 s8, s5, 3
    s_lshr_b32 s9, s7, 2
    s_add_u32 s8, s8, s9
    s_lshl_b32 s9, s6, 2
    s_and_b32 s10, s7, 3
    s_add_u32 s9, s9, s10
    s_mul_i32 s11, s8, 81920
    v_mov_b32 v1, 0
    s_lshl_b32 s13, s9, 2
    s_add_u32 s13, s13, s5
    s_lshl_b32 s13, s13, 7
    s_add_u32 s13, s13, 10199040
    s_load_dword s12, s[48:49], s13 glc
L_spoll_14:
    s_waitcnt lgkmcnt(0)
    s_cmp_ge_u32 s12, 80
    s_cbranch_scc1 L_sdone_15
    s_add_u32 s50, s50, 1
    s_cmp_gt_u32 s50, 100000
    s_cbranch_scc1 L_exit
    s_sleep 8
    s_cmp_ge_u32 s12, 24
    s_cbranch_scc1 L_near_16
    s_sleep 32
L_near_16:
    s_load_dword s12, s[48:49], s13 glc
    s_branch L_spoll_14
L_sdone_15:
    s_mul_i32 s10, s9, 10240
    s_add_u32 s11, s11, s10
    s_add_u32 s11, s11, 5242880
    v_lshlrev_b32 v1, 4, v0
    buffer_load_dwordx4 v[16:19], v1, s[52:55], s11 offen sc1
    s_add_u32 s11, s11, 1024
    buffer_load_dwordx4 v[20:23], v1, s[52:55], s11 offen sc1
    s_add_u32 s11, s11, 1024
    buffer_load_dwordx4 v[24:27], v1, s[52:55], s11 offen sc1
    s_add_u32 s11, s11, 1024
    buffer_load_dwordx4 v[28:31], v1, s[52:55], s11 offen sc1
    s_add_u32 s11, s11, 1024
    buffer_load_dwordx4 v[32:35], v1, s[52:55], s11 offen sc1
    s_add_u32 s11, s11, 1024
    buffer_load_dwordx4 v[36:39], v1, s[52:55], s11 offen sc1
    s_add_u32 s11, s11, 1024
    buffer_load_dwordx4 v[40:43], v1, s[52:55], s11 offen sc1
    s_add_u32 s11, s11, 1024
    buffer_load_dwordx4 v[44:47], v1, s[52:55], s11 offen sc1
    s_add_u32 s11, s11, 1024
    buffer_load_dwordx4 v[48:51], v1, s[52:55], s11 offen sc1
    s_add_u32 s11, s11, 1024
    buffer_load_dwordx4 v[52:55], v1, s[52:55], s11 offen sc1
    s_add_u32 s11, s11, 1024
    v_add_u32 v1, 143360, v1
    s_waitcnt vmcnt(9)
    ds_write_b128 v1, v[16:19] offset:0
    s_waitcnt vmcnt(8)
    ds_write_b128 v1, v[20:23] offset:1024
    s_waitcnt vmcnt(7)
    ds_write_b128 v1, v[24:27] offset:2048
    s_waitcnt vmcnt(6)
    ds_write_b128 v1, v[28:31] offset:3072
    s_waitcnt vmcnt(5)
    ds_write_b128 v1, v[32:35] offset:4096
    s_waitcnt vmcnt(4)
    ds_write_b128 v1, v[36:39] offset:5120
    s_waitcnt vmcnt(3)
    ds_write_b128 v1, v[40:43] offset:6144
    s_waitcnt vmcnt(2)
    ds_write_b128 v1, v[44:47] offset:7168
    s_waitcnt vmcnt(1)
    ds_write_b128 v1, v[48:51] offset:8192
    s_waitcnt vmcnt(0)
    ds_write_b128 v1, v[52:55] offset:9216
    s_waitcnt lgkmcnt(0)
    s_barrier
    s_branch L_end
L_aux:
    s_sub_u32 s8, s7, s8
    s_and_b32 s15, s4, 3
    s_mov_b32 s35, 0
    v_mov_b32 v230, 0
    s_mov_b32 s71, 0
    s_mul_i32 s69, s4, 20480
    s_lshl_b32 s9, s5, 4
    s_lshl_b32 s10, s6, 3
    s_add_u32 s9, s9, s10
    s_add_u32 s9, s9, s8
    v_and_b32 v238, 3, v0
    v_lshlrev_b32 v238, 2, v238
    s_cmp_ge_u32 s8, 8
    s_cbranch_scc1 L_nolnwg
    s_cmp_lt_u32 s4, 4
    s_cbranch_scc1 L_lnw
    s_lshl_b32 s51, s9, 2
    s_add_u32 s51, s51, s15
    s_branch L_par
L_nolnwg:
    s_mul_i32 s10, s5, 12
    s_lshl_b32 s11, s6, 2
    s_add_u32 s10, s10, s11
    s_add_u32 s10, s10, s8
    s_lshl_b32 s10, s10, 3
    s_add_u32 s10, s10, s4
    s_add_u32 s51, s10, 192
    s_lshl_b32 s10, s6, 4
    s_add_u32 s10, s10, s8
    s_cmp_lg_u32 s10, 8
    s_cbranch_scc1 L_par
    s_lshl_b32 s10, s5, 15
    s_lshl_b32 s11, s4, 12
    s_add_u32 s10, s10, s11
    s_add_u32 s10, s10, 10092544
    v_lshlrev_b32 v1, 4, v0
    s_mov_b32 s35, 5
    v_pk_mov_b32 v[4:5], 0, 0
    v_pk_mov_b32 v[6:7], 0, 0
    buffer_store_dwordx4 v[4:7], v1, s[52:55], s10 offen offset:0 sc1
    buffer_store_dwordx4 v[4:7], v1, s[52:55], s10 offen offset:1024 sc1
    buffer_store_dwordx4 v[4:7], v1, s[52:55], s10 offen offset:2048 sc1
    buffer_store_dwordx4 v[4:7], v1, s[52:55], s10 offen offset:3072 sc1
L_par:
    s_lshl_b32 s10, s51, 8
    v_lshl_add_u32 v1, v0, 2, s10
    global_load_dword v240, v1, s[18:19] nt
    global_load_dword v241, v1, s[20:21] nt
    global_load_dword v242, v1, s[22:23] nt
    global_load_dword v243, v1, s[24:25] nt
    global_load_dword v244, v1, s[26:27] nt
    global_load_dword v245, v1, s[28:29] nt
    s_lshl_b32 s10, s51, 1
    v_mov_b32 v1, s10
    global_load_ushort v246, v1, s[30:31]
    global_load_ushort v147, v1, s[32:33]
    s_cmp_lt_u32 s8, 8
    s_cbranch_scc1 L_wrole
    s_cmp_lg_u32 s35, 5
    s_cbranch_scc1 L_cs
    s_waitcnt vmcnt(8)
    s_barrier
    s_cmp_lg_u32 s4, 0
    s_cbranch_scc1 L_cs
    s_lshl_b32 s10, s5, 2
    v_mov_b32 v2, 1
    v_mov_b32 v4, 0
    s_mov_b64 exec, 1
    buffer_store_dword v2, v4, s[64:67], s10 offen sc1
    s_mov_b64 exec, -1
    s_waitcnt vmcnt(1)
L_cs:
    s_mov_b32 s35, 0
    s_sub_u32 s9, s8, 8
    s_lshl_b32 s10, s5, 2
    s_lshl_b32 s10, s10, s6
    s_add_u32 s9, s9, s10
    s_cmp_eq_u32 s6, 0
    s_cselect_b32 s10, 8, 3
    s_movk_i32 s11, 120
    s_mul_i32 s9, s9, s10
    s_add_u32 s9, s9, s4
    s_cmp_ge_u32 s4, s10
    s_cbranch_scc1 L_kgen
    s_cmp_ge_u32 s9, s11
    s_cbranch_scc1 L_kgen
    s_and_b32 s15, s9, 3
    s_lshr_b32 s9, s9, 2
    s_mul_i32 s10, s6, 30
    s_add_u32 s9, s9, s10
    s_mul_i32 s12, s15, 552960
    s_lshl_b32 s11, s9, 6
    s_add_u32 s71, s12, s11
    v_and_b32 v4, 31, v0
    v_lshlrev_b32 v4, 1, v4
    v_add_u32 v4, s11, v4
    global_load_ushort v145, v4, s[38:39]
    v_lshrrev_b32 v2, 2, v0
    v_and_b32 v3, 3, v0
    v_mul_u32_u24 v1, 3456, v2
    v_lshl_add_u32 v230, v3, 4, v1
    s_mov_b32 s35, 2
    s_branch L_kgen
L_wrole:
    s_barrier
    s_mov_b32 s60, s40
    s_mov_b32 s61, s41
    s_mov_b32 s62, 0x21c000
    s_mov_b32 s63, 0x20000
    v_lshrrev_b32 v8, 3, v0
    v_mul_u32_u24 v8, 1280, v8
    v_and_b32 v9, 7, v0
    v_lshl_add_u32 v8, v9, 4, v8
    s_lshl_b32 s8, s9, 2
    s_add_u32 s8, s8, s15
    s_add_u32 s10, s8, 0
    s_mul_i32 s11, s10, 6554
    s_lshr_b32 s11, s11, 16
    s_mul_i32 s70, s11, 10
    s_sub_u32 s70, s10, s70
    s_mul_i32 s13, s11, 40960
    s_lshl_b32 s71, s70, 7
    s_add_u32 s13, s13, s71
    s_mul_i32 s71, s70, 216
    s_mul_i32 s70, s11, 43
    s_lshr_b32 s70, s70, 8
    s_mul_i32 s70, s70, 3
    s_sub_u32 s11, s11, s70
    s_sub_u32 s70, s11, s70
    s_cmp_ge_u32 s70, 3
    s_cselect_b32 s70, 24, 0
    s_add_u32 s11, s11, s70
    s_add_u32 s71, s71, s11
    s_lshl_b32 s71, s71, 10
    s_add_u32 s96, s71, 7864320
    buffer_load_dwordx4 v[164:167], v8, s[60:63], s13 offen nt
    s_add_u32 s13, s13, 10240
    buffer_load_dwordx4 v[168:171], v8, s[60:63], s13 offen nt
    s_add_u32 s13, s13, 10240
    buffer_load_dwordx4 v[172:175], v8, s[60:63], s13 offen nt
    s_add_u32 s13, s13, 10240
    buffer_load_dwordx4 v[176:179], v8, s[60:63], s13 offen nt
    s_add_u32 s13, s13, 10240
    s_add_u32 s10, s8, 256
    s_mul_i32 s11, s10, 6554
    s_lshr_b32 s11, s11, 16
    s_mul_i32 s70, s11, 10
    s_sub_u32 s70, s10, s70
    s_mul_i32 s13, s11, 40960
    s_lshl_b32 s71, s70, 7
    s_add_u32 s13, s13, s71
    s_mul_i32 s71, s70, 216
    s_mul_i32 s70, s11, 43
    s_lshr_b32 s70, s70, 8
    s_mul_i32 s70, s70, 3
    s_sub_u32 s11, s11, s70
    s_sub_u32 s70, s11, s70
    s_cmp_ge_u32 s70, 3
    s_cselect_b32 s70, 24, 0
    s_add_u32 s11, s11, s70
    s_add_u32 s71, s71, s11
    s_lshl_b32 s71, s71, 10
    s_add_u32 s97, s71, 7864320
    buffer_load_dwordx4 v[180:183], v8, s[60:63], s13 offen nt
    s_add_u32 s13, s13, 10240
    buffer_load_dwordx4 v[184:187], v8, s[60:63], s13 offen nt
    s_add_u32 s13, s13, 10240
    buffer_load_dwordx4 v[188:191], v8, s[60:63], s13 offen nt
    s_add_u32 s13, s13, 10240
    buffer_load_dwordx4 v[192:195], v8, s[60:63], s13 offen nt
    s_add_u32 s13, s13, 10240
    s_add_u32 s10, s8, 512
    s_mul_i32 s11, s10, 6554
    s_lshr_b32 s11, s11, 16
    s_mul_i32 s70, s11, 10
    s_sub_u32 s70, s10, s70
    s_mul_i32 s13, s11, 40960
    s_lshl_b32 s71, s70, 7
    s_add_u32 s13, s13, s71
    s_mul_i32 s71, s70, 216
    s_mul_i32 s70, s11, 43
    s_lshr_b32 s70, s70, 8
    s_mul_i32 s70, s70, 3
    s_sub_u32 s11, s11, s70
    s_sub_u32 s70, s11, s70
    s_cmp_ge_u32 s70, 3
    s_cselect_b32 s70, 24, 0
    s_add_u32 s11, s11, s70
    s_add_u32 s71, s71, s11
    s_lshl_b32 s71, s71, 10
    s_add_u32 s98, s71, 7864320
    s_cmp_lt_u32 s10, 540
    s_cselect_b32 s13, s13, 0x7f000000
    s_cselect_b32 s98, s98, 0x7f000000
    buffer_load_dwordx4 v[196:199], v8, s[60:63], s13 offen nt
    s_add_u32 s13, s13, 10240
    buffer_load_dwordx4 v[200:203], v8, s[60:63], s13 offen nt
    s_add_u32 s13, s13, 10240
    buffer_load_dwordx4 v[148:151], v8, s[60:63], s13 offen nt
    s_add_u32 s13, s13, 10240
    buffer_load_dwordx4 v[152:155], v8, s[60:63], s13 offen nt
    s_add_u32 s13, s13, 10240
    s_mov_b32 s35, 1
L_kgen:
    s_mov_b32 s68, 0
    s_mov_b32 m0, s69
    s_mul_i32 s13, s51, 410
    s_lshr_b32 s13, s13, 16
    s_lshl_b32 s13, s13, 4
    s_and_b32 s100, s2, 15
    s_add_u32 s100, s100, s13
    s_lshl_b32 s100, s100, 7
    s_add_u32 s100, s100, 10190848
    s_mov_b32 s101, 0
    v_mov_b32 v146, 0
    v_mov_b32 v253, 0
    s_cmp_lt_u32 s4, 4
    s_cbranch_scc1 L_kg_nocs
    v_lshlrev_b32 v68, 4, v0
    v_add_u32 v247, s69, v68
    v_min_u32 v70, 5, v0
    v_lshl_add_u32 v248, v70, 4, s69
    v_lshlrev_b32 v68, 6, v70
    v_lshrrev_b32 v69, 1, v70
    v_lshl_add_u32 v68, v69, 4, v68
    v_add_u32 v255, s69, v68
    v_lshlrev_b32 v68, 6, v0
    v_lshrrev_b32 v69, 1, v0
    v_lshl_add_u32 v68, v69, 4, v68
    v_add_u32 v254, s69, v68
    v_lshrrev_b32 v68, 2, v0
    v_mul_u32_u24 v68, 40960, v68
    v_and_b32 v69, 3, v0
    v_lshl_add_u32 v146, v69, 4, v68
    v_and_b32 v64, 15, v0
    v_lshrrev_b32 v65, 4, v0
    v_and_b32 v66, 1, v65
    v_lshrrev_b32 v67, 1, v65
    v_sub_u32 v68, 15, v64
    v_and_b32 v69, 1, v68
    v_sub_u32 v68, v68, v69
    v_lshlrev_b32 v68, 1, v68
    v_lshl_add_u32 v70, v65, 1, v69
    v_mul_u32_u24 v70, 160, v70
    v_add_u32 v70, v70, v68
    s_add_u32 s10, s69, 1648
    v_add_u32 v249, s10, v70
    v_lshl_add_u32 v70, v66, 1, v69
    v_mul_u32_u24 v70, 160, v70
    v_add_u32 v70, v70, v68
    v_lshl_add_u32 v70, v67, 4, v70
    s_add_u32 s10, s69, 2928
    v_add_u32 v250, s10, v70
    v_mul_u32_u24 v68, 3104, v66
    v_lshlrev_b32 v69, 3, v65
    v_sub_u32 v68, v68, v69
    v_lshl_add_u32 v68, v64, 3, v68
    s_add_u32 s10, s69, 9656
    v_add_u32 v251, s10, v68
    v_mul_u32_u24 v68, 2064, v66
    v_lshl_add_u32 v68, v67, 8, v68
    v_lshl_add_u32 v68, v64, 3, v68
    s_add_u32 s10, s69, 15856
    v_add_u32 v252, s10, v68
    v_lshlrev_b32 v68, 2, v66
    v_lshrrev_b32 v70, 2, v64
    v_add_u32 v68, v68, v70
    v_mul_u32_u24 v68, 81920, v68
    v_lshl_add_u32 v68, v67, 6, v68
    v_and_b32 v70, 3, v64
    v_lshl_add_u32 v253, v70, 4, v68
    s_add_u32 s10, s69, 5504
    v_lshlrev_b32 v68, 5, v64
    v_lshl_add_u32 v68, v65, 4, v68
    v_add_u32 v237, s10, v68
    v_sub_u32 v70, v69, v64
    v_add_u32 v70, 15, v70
    v_sub_u32 v69, v64, v69
    v_lshrrev_b32 v68, 4, v70
    v_lshlrev_b32 v68, 4, v68
    v_lshl_add_u32 v68, v70, 3, v68
    v_add_u32 v231, s69, v68
    v_add_u32 v70, 4, v70
    v_lshrrev_b32 v68, 4, v70
    v_lshlrev_b32 v68, 4, v68
    v_lshl_add_u32 v68, v70, 3, v68
    v_add_u32 v236, s69, v68
    v_mov_b32 v64, 0xffff
    v_mov_b32 v65, 0xffff0000
    v_mov_b32 v66, -1
    v_cmp_eq_u32 vcc, -16, v69
    s_nop 1
    v_cndmask_b32 v204, 0, v64, vcc
    v_cmp_eq_u32 vcc, -15, v69
    s_nop 1
    v_cndmask_b32 v204, v204, v65, vcc
    v_cmp_eq_u32 vcc, -12, v69
    s_nop 1
    v_cndmask_b32 v224, 0, v66, vcc
    v_cmp_eq_u32 vcc, -13, v69
    s_nop 1
    v_cndmask_b32 v224, v224, v64, vcc
    v_cmp_eq_u32 vcc, -11, v69
    s_nop 1
    v_cndmask_b32 v224, v224, v65, vcc
    v_cmp_eq_u32 vcc, -14, v69
    s_nop 1
    v_cndmask_b32 v205, 0, v64, vcc
    v_cmp_eq_u32 vcc, -13, v69
    s_nop 1
    v_cndmask_b32 v205, v205, v65, vcc
    v_cmp_eq_u32 vcc, -10, v69
    s_nop 1
    v_cndmask_b32 v225, 0, v66, vcc
    v_cmp_eq_u32 vcc, -11, v69
    s_nop 1
    v_cndmask_b32 v225, v225, v64, vcc
    v_cmp_eq_u32 vcc, -9, v69
    s_nop 1
    v_cndmask_b32 v225, v225, v65, vcc
    v_cmp_eq_u32 vcc, -12, v69
    s_nop 1
    v_cndmask_b32 v206, 0, v64, vcc
    v_cmp_eq_u32 vcc, -11, v69
    s_nop 1
    v_cndmask_b32 v206, v206, v65, vcc
    v_cmp_eq_u32 vcc, -8, v69
    s_nop 1
    v_cndmask_b32 v226, 0, v66, vcc
    v_cmp_eq_u32 vcc, -9, v69
    s_nop 1
    v_cndmask_b32 v226, v226, v64, vcc
    v_cmp_eq_u32 vcc, -7, v69
    s_nop 1
    v_cndmask_b32 v226, v226, v65, vcc
    v_cmp_eq_u32 vcc, -10, v69
    s_nop 1
    v_cndmask_b32 v207, 0, v64, vcc
    v_cmp_eq_u32 vcc, -9, v69
    s_nop 1
    v_cndmask_b32 v207, v207, v65, vcc
    v_cmp_eq_u32 vcc, -6, v69
    s_nop 1
    v_cndmask_b32 v227, 0, v66, vcc
    v_cmp_eq_u32 vcc, -7, v69
    s_nop 1
    v_cndmask_b32 v227, v227, v64, vcc
    v_cmp_eq_u32 vcc, -5, v69
    s_nop 1
    v_cndmask_b32 v227, v227, v65, vcc
L_kg_nocs:
    v_and_b32 v2, 31, v0
    v_mul_u32_u24 v2, 272, v2
    v_lshrrev_b32 v3, 5, v0
    v_lshl_add_u32 v2, v3, 4, v2
    v_add_u32 v228, s69, v2
    v_pk_mov_b32 v[208:209], 0, 0
    v_pk_mov_b32 v[210:211], 0, 0
    v_pk_mov_b32 v[212:213], 0, 0
    v_pk_mov_b32 v[214:215], 0, 0
    v_pk_mov_b32 v[216:217], 0, 0
    v_pk_mov_b32 v[218:219], 0, 0
    v_pk_mov_b32 v[220:221], 0, 0
    v_pk_mov_b32 v[222:223], 0, 0
    s_mov_b32 s3, 0
    s_cmp_eq_u32 s35, 1
    s_cbranch_scc1 L_kw12
    s_waitcnt vmcnt(1)
L_kw12:
    s_waitcnt vmcnt(12)
    v_lshlrev_b32 v3, 16, v246
    v_mul_f32 v3, 0x3fb8aa3b, v3
    v_exp_f32 v3, v3
    s_nop 0
    v_cvt_pk_bf16_f32 v3, v3, v3
    v_lshlrev_b32 v229, 16, v3
    s_cmp_eq_u32 s35, 1
    s_cbranch_scc1 L_w2mid
L_kg_loop:
    v_and_b32 v4, 0xffff0000, v240
    v_lshlrev_b32 v240, 16, v240
    v_and_b32 v5, 0xffff0000, v241
    v_lshlrev_b32 v241, 16, v241
    v_and_b32 v6, 0xffff0000, v242
    v_lshlrev_b32 v242, 16, v242
    v_and_b32 v7, 0xffff0000, v243
    v_lshlrev_b32 v243, 16, v243
    v_and_b32 v8, 0xffff0000, v244
    v_lshlrev_b32 v244, 16, v244
    v_and_b32 v9, 0xffff0000, v245
    v_lshlrev_b32 v245, 16, v245
    v_mul_f32 v4, v229, v4
    v_mul_f32 v5, v229, v5
    v_mul_f32 v6, v229, v6
    v_mul_f32 v7, v229, v7
    v_mul_f32 v4, 0x3fb8aa3b, v4
    v_mul_f32 v5, 0x3e22f983, v5
    v_mul_f32 v20, 0x3f800000, v4
    v_mul_f32 v21, 0x3f800000, v5
    v_fract_f32 v21, v21
    v_exp_f32 v20, v20
    v_cos_f32 v10, v21
    v_sin_f32 v11, v21
    s_nop 0
    v_pk_mul_f32 v[10:11], v[10:11], v[20:21] op_sel:[0,0] op_sel_hi:[1,0]
    v_mul_f32 v20, 0x41000000, v4
    v_mul_f32 v21, 0x41000000, v5
    v_fract_f32 v21, v21
    v_exp_f32 v20, v20
    v_cos_f32 v12, v21
    v_sin_f32 v13, v21
    s_nop 0
    v_pk_mul_f32 v[12:13], v[12:13], v[20:21] op_sel:[0,0] op_sel_hi:[1,0] neg_hi:[0,1]
    v_mul_f32 v20, 0x43800000, v4
    v_mul_f32 v21, 0x43800000, v5
    v_fract_f32 v21, v21
    v_exp_f32 v20, v20
    v_cos_f32 v14, v21
    v_sin_f32 v15, v21
    s_nop 0
    v_pk_mul_f32 v[14:15], v[14:15], v[20:21] op_sel:[0,0] op_sel_hi:[1,0]
    v_pk_mul_f32 v[20:21], v[8:9], v[6:7] op_sel:[0,0] op_sel_hi:[0,1]
    v_pk_fma_f32 v[16:17], v[8:9], v[6:7], v[20:21] op_sel:[1,1,0] op_sel_hi:[1,0,1] neg_lo:[0,1,0]
    v_mov_b32 v28, 0x3f80
    ds_write_addtid_b32 v28 offset:8704
    v_cvt_pk_bf16_f32 v24, v16, v17
    ds_write_addtid_b32 v24 offset:0
    s_cmp_lg_u32 s35, 2
    s_cbranch_scc1 L_kg_nl0
    buffer_load_dwordx4 v[164:167], v230, s[60:63], s71 offen
    s_add_u32 s71, s71, 55296
L_kg_nl0:
    v_cvt_pk_bf16_f32 v25, v12, v13
    ds_write_addtid_b32 v25 offset:8976
    v_pk_mul_f32 v[20:21], v[16:17], v[10:11] op_sel:[0,0] op_sel_hi:[0,1]
    v_pk_fma_f32 v[34:35], v[16:17], v[10:11], v[20:21] op_sel:[1,1,0] op_sel_hi:[1,0,1] neg_lo:[0,1,0]
    v_cvt_pk_bf16_f32 v26, v34, v35
    ds_write_addtid_b32 v26 offset:272
    s_cmp_lg_u32 s35, 2
    s_cbranch_scc1 L_kg_nl1
    buffer_load_dwordx4 v[168:171], v230, s[60:63], s71 offen
    s_add_u32 s71, s71, 55296
L_kg_nl1:
    v_pk_mul_f32 v[22:23], v[12:13], v[12:13] op_sel:[0,0] op_sel_hi:[0,1]
    v_pk_fma_f32 v[60:61], v[12:13], v[12:13], v[22:23] op_sel:[1,1,0] op_sel_hi:[1,0,1] neg_lo:[0,1,0]
    v_cvt_pk_bf16_f32 v27, v60, v61
    ds_write_addtid_b32 v27 offset:9248
    v_pk_mul_f32 v[20:21], v[34:35], v[10:11] op_sel:[0,0] op_sel_hi:[0,1]
    v_pk_fma_f32 v[36:37], v[34:35], v[10:11], v[20:21] op_sel:[1,1,0] op_sel_hi:[1,0,1] neg_lo:[0,1,0]
    v_cvt_pk_bf16_f32 v24, v36, v37
    ds_write_addtid_b32 v24 offset:544
    s_cmp_lg_u32 s35, 2
    s_cbranch_scc1 L_kg_nl2
    buffer_load_dwordx4 v[172:175], v230, s[60:63], s71 offen
    s_add_u32 s71, s71, 55296
L_kg_nl2:
    v_pk_mul_f32 v[22:23], v[60:61], v[12:13] op_sel:[0,0] op_sel_hi:[0,1]
    v_pk_fma_f32 v[62:63], v[60:61], v[12:13], v[22:23] op_sel:[1,1,0] op_sel_hi:[1,0,1] neg_lo:[0,1,0]
    v_cvt_pk_bf16_f32 v25, v62, v63
    ds_write_addtid_b32 v25 offset:9520
    v_pk_mul_f32 v[20:21], v[36:37], v[10:11] op_sel:[0,0] op_sel_hi:[0,1]
    v_pk_fma_f32 v[38:39], v[36:37], v[10:11], v[20:21] op_sel:[1,1,0] op_sel_hi:[1,0,1] neg_lo:[0,1,0]
    v_cvt_pk_bf16_f32 v26, v38, v39
    ds_write_addtid_b32 v26 offset:816
    s_cmp_lg_u32 s35, 2
    s_cbranch_scc1 L_kg_nl3
    buffer_load_dwordx4 v[176:179], v230, s[60:63], s71 offen
    s_add_u32 s71, s71, 55296
L_kg_nl3:
    v_pk_mul_f32 v[22:23], v[62:63], v[12:13] op_sel:[0,0] op_sel_hi:[0,1]
    v_pk_fma_f32 v[60:61], v[62:63], v[12:13], v[22:23] op_sel:[1,1,0] op_sel_hi:[1,0,1] neg_lo:[0,1,0]
    v_cvt_pk_bf16_f32 v27, v60, v61
    ds_write_addtid_b32 v27 offset:9792
    v_pk_mul_f32 v[20:21], v[38:39], v[10:11] op_sel:[0,0] op_sel_hi:[0,1]
    v_pk_fma_f32 v[40:41], v[38:39], v[10:11], v[20:21] op_sel:[1,1,0] op_sel_hi:[1,0,1] neg_lo:[0,1,0]
    v_cvt_pk_bf16_f32 v24, v40, v41
    ds_write_addtid_b32 v24 offset:2176
    s_cmp_lg_u32 s35, 2
    s_cbranch_scc1 L_kg_nl4
    buffer_load_dwordx4 v[180:183], v230, s[60:63], s71 offen
    s_add_u32 s71, s71, 55296
L_kg_nl4:
    v_pk_mul_f32 v[22:23], v[60:61], v[12:13] op_sel:[0,0] op_sel_hi:[0,1]
    v_pk_fma_f32 v[62:63], v[60:61], v[12:13], v[22:23] op_sel:[1,1,0] op_sel_hi:[1,0,1] neg_lo:[0,1,0]
    v_cvt_pk_bf16_f32 v25, v62, v63
    ds_write_addtid_b32 v25 offset:10064
    v_pk_mul_f32 v[20:21], v[40:41], v[10:11] op_sel:[0,0] op_sel_hi:[0,1]
    v_pk_fma_f32 v[42:43], v[40:41], v[10:11], v[20:21] op_sel:[1,1,0] op_sel_hi:[1,0,1] neg_lo:[0,1,0]
    v_cvt_pk_bf16_f32 v26, v42, v43
    ds_write_addtid_b32 v26 offset:2448
    s_cmp_lg_u32 s35, 2
    s_cbranch_scc1 L_kg_nl5
    buffer_load_dwordx4 v[184:187], v230, s[60:63], s71 offen
    s_add_u32 s71, s71, 55296
L_kg_nl5:
    v_pk_mul_f32 v[22:23], v[62:63], v[12:13] op_sel:[0,0] op_sel_hi:[0,1]
    v_pk_fma_f32 v[60:61], v[62:63], v[12:13], v[22:23] op_sel:[1,1,0] op_sel_hi:[1,0,1] neg_lo:[0,1,0]
    v_cvt_pk_bf16_f32 v27, v60, v61
    ds_write_addtid_b32 v27 offset:10336
    v_pk_mul_f32 v[20:21], v[42:43], v[10:11] op_sel:[0,0] op_sel_hi:[0,1]
    v_pk_fma_f32 v[44:45], v[42:43], v[10:11], v[20:21] op_sel:[1,1,0] op_sel_hi:[1,0,1] neg_lo:[0,1,0]
    v_cvt_pk_bf16_f32 v24, v44, v45
    ds_write_addtid_b32 v24 offset:2720
    s_cmp_lg_u32 s35, 2
    s_cbranch_scc1 L_kg_nl6
    buffer_load_dwordx4 v[188:191], v230, s[60:63], s71 offen
    s_add_u32 s71, s71, 55296
L_kg_nl6:
    v_pk_mul_f32 v[22:23], v[60:61], v[12:13] op_sel:[0,0] op_sel_hi:[0,1]
    v_pk_fma_f32 v[62:63], v[60:61], v[12:13], v[22:23] op_sel:[1,1,0] op_sel_hi:[1,0,1] neg_lo:[0,1,0]
    v_cvt_pk_bf16_f32 v25, v62, v63
    ds_write_addtid_b32 v25 offset:10608
    v_pk_mul_f32 v[20:21], v[44:45], v[10:11] op_sel:[0,0] op_sel_hi:[0,1]
    v_pk_fma_f32 v[46:47], v[44:45], v[10:11], v[20:21] op_sel:[1,1,0] op_sel_hi:[1,0,1] neg_lo:[0,1,0]
    v_cvt_pk_bf16_f32 v26, v46, v47
    ds_write_addtid_b32 v26 offset:2992
    s_cmp_lg_u32 s35, 2
    s_cbranch_scc1 L_kg_nl7
    buffer_load_dwordx4 v[192:195], v230, s[60:63], s71 offen
    s_add_u32 s71, s71, 55296
L_kg_nl7:
    v_pk_mul_f32 v[22:23], v[62:63], v[12:13] op_sel:[0,0] op_sel_hi:[0,1]
    v_pk_fma_f32 v[60:61], v[62:63], v[12:13], v[22:23] op_sel:[1,1,0] op_sel_hi:[1,0,1] neg_lo:[0,1,0]
    v_cvt_pk_bf16_f32 v27, v60, v61
    ds_write_addtid_b32 v27 offset:10880
    v_pk_mul_f32 v[20:21], v[46:47], v[10:11] op_sel:[0,0] op_sel_hi:[0,1]
    v_pk_fma_f32 v[48:49], v[46:47], v[10:11], v[20:21] op_sel:[1,1,0] op_sel_hi:[1,0,1] neg_lo:[0,1,0]
    s_cmp_lg_u32 s35, 2
    s_cbranch_scc1 L_kg_nl8
    buffer_load_dwordx4 v[196:199], v230, s[60:63], s71 offen
    s_add_u32 s71, s71, 55296
L_kg_nl8:
    v_pk_mul_f32 v[22:23], v[60:61], v[12:13] op_sel:[0,0] op_sel_hi:[0,1]
    v_pk_fma_f32 v[62:63], v[60:61], v[12:13], v[22:23] op_sel:[1,1,0] op_sel_hi:[1,0,1] neg_lo:[0,1,0]
    v_cvt_pk_bf16_f32 v24, v62, v63
    ds_write_addtid_b32 v24 offset:11152
    v_pk_mul_f32 v[20:21], v[16:17], v[14:15] op_sel:[0,0] op_sel_hi:[0,1]
    v_pk_fma_f32 v[56:57], v[16:17], v[14:15], v[20:21] op_sel:[1,1,0] op_sel_hi:[1,0,1] neg_lo:[0,1,0]
    v_cvt_pk_bf16_f32 v25, v56, v57
    ds_write_addtid_b32 v25 offset:1088
    s_cmp_lg_u32 s35, 2
    s_cbranch_scc1 L_kg_nl9
    buffer_load_dwordx4 v[200:203], v230, s[60:63], s71 offen
    s_add_u32 s71, s71, 55296
L_kg_nl9:
    v_pk_mul_f32 v[22:23], v[62:63], v[12:13] op_sel:[0,0] op_sel_hi:[0,1]
    v_pk_fma_f32 v[60:61], v[62:63], v[12:13], v[22:23] op_sel:[1,1,0] op_sel_hi:[1,0,1] neg_lo:[0,1,0]
    v_cvt_pk_bf16_f32 v26, v60, v61
    ds_write_addtid_b32 v26 offset:11424
    v_pk_mul_f32 v[20:21], v[36:37], v[14:15] op_sel:[0,0] op_sel_hi:[0,1]
    v_pk_fma_f32 v[58:59], v[36:37], v[14:15], v[20:21] op_sel:[1,1,0] op_sel_hi:[1,0,1] neg_lo:[0,1,0]
    v_cvt_pk_bf16_f32 v27, v58, v59
    ds_write_addtid_b32 v27 offset:1360
    v_pk_mul_f32 v[22:23], v[60:61], v[12:13] op_sel:[0,0] op_sel_hi:[0,1]
    v_pk_fma_f32 v[62:63], v[60:61], v[12:13], v[22:23] op_sel:[1,1,0] op_sel_hi:[1,0,1] neg_lo:[0,1,0]
    v_cvt_pk_bf16_f32 v24, v62, v63
    ds_write_addtid_b32 v24 offset:11696
    v_pk_mul_f32 v[20:21], v[40:41], v[14:15] op_sel:[0,0] op_sel_hi:[0,1]
    v_pk_fma_f32 v[56:57], v[40:41], v[14:15], v[20:21] op_sel:[1,1,0] op_sel_hi:[1,0,1] neg_lo:[0,1,0]
    v_cvt_pk_bf16_f32 v25, v56, v57
    ds_write_addtid_b32 v25 offset:1632
    v_pk_mul_f32 v[22:23], v[62:63], v[12:13] op_sel:[0,0] op_sel_hi:[0,1]
    v_pk_fma_f32 v[60:61], v[62:63], v[12:13], v[22:23] op_sel:[1,1,0] op_sel_hi:[1,0,1] neg_lo:[0,1,0]
    v_cvt_pk_bf16_f32 v26, v60, v61
    ds_write_addtid_b32 v26 offset:11968
    v_pk_mul_f32 v[20:21], v[44:45], v[14:15] op_sel:[0,0] op_sel_hi:[0,1]
    v_pk_fma_f32 v[58:59], v[44:45], v[14:15], v[20:21] op_sel:[1,1,0] op_sel_hi:[1,0,1] neg_lo:[0,1,0]
    v_cvt_pk_bf16_f32 v27, v58, v59
    ds_write_addtid_b32 v27 offset:1904
    s_lshl_b32 s10, s3, 2
    s_and_b32 s10, s10, s4
    s_cbranch_scc1 L_eu0
L_kg_ne1:
    v_pk_mul_f32 v[22:23], v[60:61], v[12:13] op_sel:[0,0] op_sel_hi:[0,1]
    v_pk_fma_f32 v[62:63], v[60:61], v[12:13], v[22:23] op_sel:[1,1,0] op_sel_hi:[1,0,1] neg_lo:[0,1,0]
    v_cvt_pk_bf16_f32 v24, v62, v63
    ds_write_addtid_b32 v24 offset:12240
    v_pk_mul_f32 v[20:21], v[48:49], v[14:15] op_sel:[0,0] op_sel_hi:[0,1]
    v_pk_fma_f32 v[56:57], v[48:49], v[14:15], v[20:21] op_sel:[1,1,0] op_sel_hi:[1,0,1] neg_lo:[0,1,0]
    v_cvt_pk_bf16_f32 v25, v56, v57
    ds_write_addtid_b32 v25 offset:3264
    v_pk_mul_f32 v[22:23], v[62:63], v[12:13] op_sel:[0,0] op_sel_hi:[0,1]
    v_pk_fma_f32 v[60:61], v[62:63], v[12:13], v[22:23] op_sel:[1,1,0] op_sel_hi:[1,0,1] neg_lo:[0,1,0]
    v_cvt_pk_bf16_f32 v26, v60, v61
    ds_write_addtid_b32 v26 offset:12512
    v_pk_mul_f32 v[20:21], v[14:15], v[14:15] op_sel:[0,0] op_sel_hi:[0,1]
    v_pk_fma_f32 v[52:53], v[14:15], v[14:15], v[20:21] op_sel:[1,1,0] op_sel_hi:[1,0,1] neg_lo:[0,1,0]
    s_cmp_eq_u32 s35, 6
    s_cbranch_scc1 L_w2sig
L_kg_nsig:
    v_pk_mul_f32 v[22:23], v[60:61], v[12:13] op_sel:[0,0] op_sel_hi:[0,1]
    v_pk_fma_f32 v[62:63], v[60:61], v[12:13], v[22:23] op_sel:[1,1,0] op_sel_hi:[1,0,1] neg_lo:[0,1,0]
    v_cvt_pk_bf16_f32 v27, v62, v63
    ds_write_addtid_b32 v27 offset:12784
    v_pk_mul_f32 v[20:21], v[16:17], v[52:53] op_sel:[0,0] op_sel_hi:[0,1]
    v_pk_fma_f32 v[56:57], v[16:17], v[52:53], v[20:21] op_sel:[1,1,0] op_sel_hi:[1,0,1] neg_lo:[0,1,0]
    v_cvt_pk_bf16_f32 v24, v56, v57
    ds_write_addtid_b32 v24 offset:5440
    v_pk_mul_f32 v[22:23], v[62:63], v[12:13] op_sel:[0,0] op_sel_hi:[0,1]
    v_pk_fma_f32 v[60:61], v[62:63], v[12:13], v[22:23] op_sel:[1,1,0] op_sel_hi:[1,0,1] neg_lo:[0,1,0]
    v_cvt_pk_bf16_f32 v25, v60, v61
    ds_write_addtid_b32 v25 offset:13056
    v_pk_mul_f32 v[20:21], v[40:41], v[52:53] op_sel:[0,0] op_sel_hi:[0,1]
    v_pk_fma_f32 v[58:59], v[40:41], v[52:53], v[20:21] op_sel:[1,1,0] op_sel_hi:[1,0,1] neg_lo:[0,1,0]
    v_cvt_pk_bf16_f32 v26, v58, v59
    ds_write_addtid_b32 v26 offset:5712
    v_pk_mul_f32 v[22:23], v[60:61], v[12:13] op_sel:[0,0] op_sel_hi:[0,1]
    v_pk_fma_f32 v[62:63], v[60:61], v[12:13], v[22:23] op_sel:[1,1,0] op_sel_hi:[1,0,1] neg_lo:[0,1,0]
    v_cvt_pk_bf16_f32 v27, v62, v63
    ds_write_addtid_b32 v27 offset:13328
    v_pk_mul_f32 v[20:21], v[48:49], v[52:53] op_sel:[0,0] op_sel_hi:[0,1]
    v_pk_fma_f32 v[56:57], v[48:49], v[52:53], v[20:21] op_sel:[1,1,0] op_sel_hi:[1,0,1] neg_lo:[0,1,0]
    v_cvt_pk_bf16_f32 v24, v56, v57
    ds_write_addtid_b32 v24 offset:5984
    v_pk_mul_f32 v[22:23], v[62:63], v[12:13] op_sel:[0,0] op_sel_hi:[0,1]
    v_pk_fma_f32 v[60:61], v[62:63], v[12:13], v[22:23] op_sel:[1,1,0] op_sel_hi:[1,0,1] neg_lo:[0,1,0]
    v_cvt_pk_bf16_f32 v25, v60, v61
    ds_write_addtid_b32 v25 offset:13600
    v_pk_mul_f32 v[20:21], v[52:53], v[14:15] op_sel:[0,0] op_sel_hi:[0,1]
    v_pk_fma_f32 v[54:55], v[52:53], v[14:15], v[20:21] op_sel:[1,1,0] op_sel_hi:[1,0,1] neg_lo:[0,1,0]
    v_pk_mul_f32 v[22:23], v[60:61], v[12:13] op_sel:[0,0] op_sel_hi:[0,1]
    v_pk_fma_f32 v[62:63], v[60:61], v[12:13], v[22:23] op_sel:[1,1,0] op_sel_hi:[1,0,1] neg_lo:[0,1,0]
    v_cvt_pk_bf16_f32 v26, v62, v63
    ds_write_addtid_b32 v26 offset:13872
    v_pk_mul_f32 v[20:21], v[16:17], v[54:55] op_sel:[0,0] op_sel_hi:[0,1]
    v_pk_fma_f32 v[56:57], v[16:17], v[54:55], v[20:21] op_sel:[1,1,0] op_sel_hi:[1,0,1] neg_lo:[0,1,0]
    v_cvt_pk_bf16_f32 v27, v56, v57
    ds_write_addtid_b32 v27 offset:7616
    v_pk_mul_f32 v[22:23], v[62:63], v[12:13] op_sel:[0,0] op_sel_hi:[0,1]
    v_pk_fma_f32 v[60:61], v[62:63], v[12:13], v[22:23] op_sel:[1,1,0] op_sel_hi:[1,0,1] neg_lo:[0,1,0]
    v_cvt_pk_bf16_f32 v24, v60, v61
    ds_write_addtid_b32 v24 offset:14144
    v_pk_mul_f32 v[20:21], v[40:41], v[54:55] op_sel:[0,0] op_sel_hi:[0,1]
    v_pk_fma_f32 v[58:59], v[40:41], v[54:55], v[20:21] op_sel:[1,1,0] op_sel_hi:[1,0,1] neg_lo:[0,1,0]
    v_cvt_pk_bf16_f32 v25, v58, v59
    ds_write_addtid_b32 v25 offset:7888
    v_pk_mul_f32 v[22:23], v[60:61], v[12:13] op_sel:[0,0] op_sel_hi:[0,1]
    v_pk_fma_f32 v[62:63], v[60:61], v[12:13], v[22:23] op_sel:[1,1,0] op_sel_hi:[1,0,1] neg_lo:[0,1,0]
    v_cvt_pk_bf16_f32 v26, v62, v63
    ds_write_addtid_b32 v26 offset:14416
    v_pk_mul_f32 v[20:21], v[48:49], v[54:55] op_sel:[0,0] op_sel_hi:[0,1]
    v_pk_fma_f32 v[56:57], v[48:49], v[54:55], v[20:21] op_sel:[1,1,0] op_sel_hi:[1,0,1] neg_lo:[0,1,0]
    v_cvt_pk_bf16_f32 v27, v56, v57
    ds_write_addtid_b32 v27 offset:8160
    v_pk_mul_f32 v[22:23], v[62:63], v[12:13] op_sel:[0,0] op_sel_hi:[0,1]
    v_pk_fma_f32 v[60:61], v[62:63], v[12:13], v[22:23] op_sel:[1,1,0] op_sel_hi:[1,0,1] neg_lo:[0,1,0]
    v_cvt_pk_bf16_f32 v24, v60, v61
    ds_write_addtid_b32 v24 offset:14688
    v_pk_mul_f32 v[20:21], v[54:55], v[14:15] op_sel:[0,0] op_sel_hi:[0,1]
    v_pk_fma_f32 v[52:53], v[54:55], v[14:15], v[20:21] op_sel:[1,1,0] op_sel_hi:[1,0,1] neg_lo:[0,1,0]
    v_pk_mul_f32 v[22:23], v[60:61], v[12:13] op_sel:[0,0] op_sel_hi:[0,1]
    v_pk_fma_f32 v[62:63], v[60:61], v[12:13], v[22:23] op_sel:[1,1,0] op_sel_hi:[1,0,1] neg_lo:[0,1,0]
    v_cvt_pk_bf16_f32 v25, v62, v63
    ds_write_addtid_b32 v25 offset:14960
    v_pk_mul_f32 v[20:21], v[16:17], v[52:53] op_sel:[0,0] op_sel_hi:[0,1]
    v_pk_fma_f32 v[56:57], v[16:17], v[52:53], v[20:21] op_sel:[1,1,0] op_sel_hi:[1,0,1] neg_lo:[0,1,0]
    v_cvt_pk_bf16_f32 v26, v56, v57
    ds_write_addtid_b32 v26 offset:4352
    v_pk_mul_f32 v[22:23], v[62:63], v[12:13] op_sel:[0,0] op_sel_hi:[0,1]
    v_pk_fma_f32 v[60:61], v[62:63], v[12:13], v[22:23] op_sel:[1,1,0] op_sel_hi:[1,0,1] neg_lo:[0,1,0]
    v_cvt_pk_bf16_f32 v27, v60, v61
    ds_write_addtid_b32 v27 offset:15232
    v_pk_mul_f32 v[20:21], v[48:49], v[52:53] op_sel:[0,0] op_sel_hi:[0,1]
    v_pk_fma_f32 v[58:59], v[48:49], v[52:53], v[20:21] op_sel:[1,1,0] op_sel_hi:[1,0,1] neg_lo:[0,1,0]
    v_cvt_pk_bf16_f32 v24, v58, v59
    ds_write_addtid_b32 v24 offset:4624
    v_pk_mul_f32 v[22:23], v[60:61], v[12:13] op_sel:[0,0] op_sel_hi:[0,1]
    v_pk_fma_f32 v[62:63], v[60:61], v[12:13], v[22:23] op_sel:[1,1,0] op_sel_hi:[1,0,1] neg_lo:[0,1,0]
    v_cvt_pk_bf16_f32 v25, v62, v63
    ds_write_addtid_b32 v25 offset:15504
    v_pk_mul_f32 v[20:21], v[52:53], v[14:15] op_sel:[0,0] op_sel_hi:[0,1]
    v_pk_fma_f32 v[54:55], v[52:53], v[14:15], v[20:21] op_sel:[1,1,0] op_sel_hi:[1,0,1] neg_lo:[0,1,0]
    v_pk_mul_f32 v[22:23], v[62:63], v[12:13] op_sel:[0,0] op_sel_hi:[0,1]
    v_pk_fma_f32 v[60:61], v[62:63], v[12:13], v[22:23] op_sel:[1,1,0] op_sel_hi:[1,0,1] neg_lo:[0,1,0]
    v_cvt_pk_bf16_f32 v26, v60, v61
    ds_write_addtid_b32 v26 offset:15776
    v_pk_mul_f32 v[20:21], v[16:17], v[54:55] op_sel:[0,0] op_sel_hi:[0,1]
    v_pk_fma_f32 v[56:57], v[16:17], v[54:55], v[20:21] op_sel:[1,1,0] op_sel_hi:[1,0,1] neg_lo:[0,1,0]
    v_cvt_pk_bf16_f32 v27, v56, v57
    ds_write_addtid_b32 v27 offset:4896
    v_pk_mul_f32 v[22:23], v[60:61], v[12:13] op_sel:[0,0] op_sel_hi:[0,1]
    v_pk_fma_f32 v[62:63], v[60:61], v[12:13], v[22:23] op_sel:[1,1,0] op_sel_hi:[1,0,1] neg_lo:[0,1,0]
    v_cvt_pk_bf16_f32 v24, v62, v63
    ds_write_addtid_b32 v24 offset:16048
    v_pk_mul_f32 v[20:21], v[48:49], v[54:55] op_sel:[0,0] op_sel_hi:[0,1]
    v_pk_fma_f32 v[58:59], v[48:49], v[54:55], v[20:21] op_sel:[1,1,0] op_sel_hi:[1,0,1] neg_lo:[0,1,0]
    v_cvt_pk_bf16_f32 v25, v58, v59
    ds_write_addtid_b32 v25 offset:5168
    v_pk_mul_f32 v[22:23], v[62:63], v[12:13] op_sel:[0,0] op_sel_hi:[0,1]
    v_pk_fma_f32 v[60:61], v[62:63], v[12:13], v[22:23] op_sel:[1,1,0] op_sel_hi:[1,0,1] neg_lo:[0,1,0]
    v_cvt_pk_bf16_f32 v26, v60, v61
    ds_write_addtid_b32 v26 offset:16320
    v_pk_mul_f32 v[20:21], v[54:55], v[14:15] op_sel:[0,0] op_sel_hi:[0,1]
    v_pk_fma_f32 v[52:53], v[54:55], v[14:15], v[20:21] op_sel:[1,1,0] op_sel_hi:[1,0,1] neg_lo:[0,1,0]
    v_pk_mul_f32 v[22:23], v[60:61], v[12:13] op_sel:[0,0] op_sel_hi:[0,1]
    v_pk_fma_f32 v[62:63], v[60:61], v[12:13], v[22:23] op_sel:[1,1,0] op_sel_hi:[1,0,1] neg_lo:[0,1,0]
    v_cvt_pk_bf16_f32 v27, v62, v63
    ds_write_addtid_b32 v27 offset:16592
    v_pk_mul_f32 v[20:21], v[16:17], v[52:53] op_sel:[0,0] op_sel_hi:[0,1]
    v_pk_fma_f32 v[56:57], v[16:17], v[52:53], v[20:21] op_sel:[1,1,0] op_sel_hi:[1,0,1] neg_lo:[0,1,0]
    v_cvt_pk_bf16_f32 v24, v56, v57
    ds_write_addtid_b32 v24 offset:6528
    v_pk_mul_f32 v[22:23], v[62:63], v[12:13] op_sel:[0,0] op_sel_hi:[0,1]
    v_pk_fma_f32 v[60:61], v[62:63], v[12:13], v[22:23] op_sel:[1,1,0] op_sel_hi:[1,0,1] neg_lo:[0,1,0]
    v_cvt_pk_bf16_f32 v25, v60, v61
    ds_write_addtid_b32 v25 offset:16864
    v_pk_mul_f32 v[20:21], v[48:49], v[52:53] op_sel:[0,0] op_sel_hi:[0,1]
    v_pk_fma_f32 v[58:59], v[48:49], v[52:53], v[20:21] op_sel:[1,1,0] op_sel_hi:[1,0,1] neg_lo:[0,1,0]
    v_cvt_pk_bf16_f32 v26, v58, v59
    ds_write_addtid_b32 v26 offset:6800
    v_pk_mul_f32 v[22:23], v[60:61], v[12:13] op_sel:[0,0] op_sel_hi:[0,1]
    v_pk_fma_f32 v[62:63], v[60:61], v[12:13], v[22:23] op_sel:[1,1,0] op_sel_hi:[1,0,1] neg_lo:[0,1,0]
    v_cvt_pk_bf16_f32 v27, v62, v63
    ds_write_addtid_b32 v27 offset:17136
    v_pk_mul_f32 v[20:21], v[52:53], v[14:15] op_sel:[0,0] op_sel_hi:[0,1]
    v_pk_fma_f32 v[54:55], v[52:53], v[14:15], v[20:21] op_sel:[1,1,0] op_sel_hi:[1,0,1] neg_lo:[0,1,0]
    s_cmp_eq_u32 s68, 1
    s_cbranch_scc1 L_eu
L_kg_ne2:
    v_pk_mul_f32 v[20:21], v[16:17], v[54:55] op_sel:[0,0] op_sel_hi:[0,1]
    v_pk_fma_f32 v[56:57], v[16:17], v[54:55], v[20:21] op_sel:[1,1,0] op_sel_hi:[1,0,1] neg_lo:[0,1,0]
    v_cvt_pk_bf16_f32 v24, v56, v57
    ds_write_addtid_b32 v24 offset:7072
    v_pk_mul_f32 v[20:21], v[48:49], v[54:55] op_sel:[0,0] op_sel_hi:[0,1]
    v_pk_fma_f32 v[58:59], v[48:49], v[54:55], v[20:21] op_sel:[1,1,0] op_sel_hi:[1,0,1] neg_lo:[0,1,0]
    v_cvt_pk_bf16_f32 v25, v58, v59
    ds_write_addtid_b32 v25 offset:7344
    s_waitcnt lgkmcnt(0)
    ds_read_b128 v[64:67], v228 offset:0
    ds_read_b128 v[68:71], v228 offset:8704
    ds_read_b128 v[72:75], v228 offset:32
    ds_read_b128 v[76:79], v228 offset:8736
    ds_read_b128 v[80:83], v228 offset:64
    ds_read_b128 v[84:87], v228 offset:8768
    ds_read_b128 v[88:91], v228 offset:96
    ds_read_b128 v[92:95], v228 offset:8800
    ds_read_b128 v[96:99], v228 offset:128
    ds_read_b128 v[100:103], v228 offset:8832
    ds_read_b128 v[104:107], v228 offset:160
    ds_read_b128 v[108:111], v228 offset:8864
    ds_read_b128 v[112:115], v228 offset:192
    ds_read_b128 v[116:119], v228 offset:8896
    ds_read_b128 v[120:123], v228 offset:224
    ds_read_b128 v[124:127], v228 offset:8928
    s_waitcnt lgkmcnt(14)
    v_mfma_f32_32x32x16_bf16 v[208:223], v[64:67], v[68:71], v[208:223]
    s_waitcnt lgkmcnt(12)
    v_mfma_f32_32x32x16_bf16 v[208:223], v[72:75], v[76:79], v[208:223]
    s_waitcnt lgkmcnt(10)
    v_mfma_f32_32x32x16_bf16 v[208:223], v[80:83], v[84:87], v[208:223]
    s_waitcnt lgkmcnt(8)
    v_mfma_f32_32x32x16_bf16 v[208:223], v[88:91], v[92:95], v[208:223]
    s_waitcnt lgkmcnt(6)
    v_mfma_f32_32x32x16_bf16 v[208:223], v[96:99], v[100:103], v[208:223]
    s_waitcnt lgkmcnt(4)
    v_mfma_f32_32x32x16_bf16 v[208:223], v[104:107], v[108:111], v[208:223]
    s_waitcnt lgkmcnt(2)
    v_mfma_f32_32x32x16_bf16 v[208:223], v[112:115], v[116:119], v[208:223]
    s_waitcnt lgkmcnt(0)
    v_mfma_f32_32x32x16_bf16 v[208:223], v[120:123], v[124:127], v[208:223]
    s_cmp_lg_u32 s3, 0
    s_cbranch_scc1 L_kg_done
    s_load_dwordx4 s[28:31], s[46:47], 0
    s_mov_b32 s3, 1
    s_cmp_lg_u32 s35, 2
    s_cbranch_scc1 L_kg_loop
    s_branch L_csum
L_eu0:
    s_waitcnt lgkmcnt(0)
    s_and_b32 s10, s28, s29
    s_and_b32 s11, s30, s31
    s_and_b32 s10, s10, s11
    s_cselect_b32 s35, 4, s35
    s_cmp_lt_u32 s35, 4
    s_cbranch_scc1 L_kg_ne1
    s_load_dword s33, s[48:49], s100 glc
    s_mov_b32 s68, 1
    s_branch L_kg_ne1
L_eu:
    s_mov_b32 s68, 0
    s_waitcnt lgkmcnt(0)
    s_cmp_ge_u32 s33, 64
    s_cbranch_scc0 L_kg_ne2
    s_lshl_b32 s10, s51, 6
    buffer_load_dwordx4 v[148:151], v146, s[52:55], s10 offen sc1
    s_add_u32 s10, s10, 655360
    buffer_load_dwordx4 v[152:155], v146, s[52:55], s10 offen sc1
    s_add_u32 s10, s10, 655360
    buffer_load_dwordx4 v[156:159], v146, s[52:55], s10 offen sc1
    s_add_u32 s10, s10, 655360
    buffer_load_dwordx4 v[160:163], v146, s[52:55], s10 offen sc1
    s_add_u32 s10, s10, 655360
    s_mov_b32 s68, 2
    s_branch L_kg_ne2
L_lnw:
    s_lshl_b32 s10, s9, 5
    s_lshl_b32 s11, s15, 3
    s_add_u32 s14, s10, s11
    s_mul_i32 s11, s14, 1280
    v_lshrrev_b32 v2, 4, v0
    v_and_b32 v3, 15, v0
    v_mul_u32_u24 v1, 2560, v2
    v_lshl_add_u32 v1, v3, 4, v1
    buffer_load_dwordx4 v[164:167], v1, s[56:59], s11 offen offset:0
    buffer_load_dwordx4 v[168:171], v1, s[56:59], s11 offen offset:256
    buffer_load_dwordx4 v[172:175], v1, s[56:59], s11 offen offset:512
    buffer_load_dwordx4 v[176:179], v1, s[56:59], s11 offen offset:768
    buffer_load_dwordx4 v[180:183], v1, s[56:59], s11 offen offset:1024
    buffer_load_dwordx4 v[184:187], v1, s[56:59], s11 offen offset:1280
    buffer_load_dwordx4 v[188:191], v1, s[56:59], s11 offen offset:1536
    buffer_load_dwordx4 v[192:195], v1, s[56:59], s11 offen offset:1792
    buffer_load_dwordx4 v[196:199], v1, s[56:59], s11 offen offset:2048
    buffer_load_dwordx4 v[200:203], v1, s[56:59], s11 offen offset:2304
    v_mov_b32 v4, 163456
    v_mov_b32 v6, 0
    v_mov_b32 v7, 0
    ds_write_b64 v4, v[6:7]
    s_waitcnt lgkmcnt(0)
    s_barrier
    s_lshl_b32 s11, s15, 4
    v_lshlrev_b32 v8, 2, v2
    v_add_u32 v8, s11, v8
    v_add_u32 v4, 0, v3
    v_mul_u32_u24 v5, 3277, v4
    v_lshrrev_b32 v5, 16, v5
    v_mul_u32_u24 v5, 9920, v5
    v_mul_u32_u24 v4, 528, v4
    v_add3_u32 v150, v4, v5, v8
    v_add_u32 v4, 16, v3
    v_mul_u32_u24 v5, 3277, v4
    v_lshrrev_b32 v5, 16, v5
    v_mul_u32_u24 v5, 9920, v5
    v_mul_u32_u24 v4, 528, v4
    v_add3_u32 v151, v4, v5, v8
    v_add_u32 v4, 32, v3
    v_mul_u32_u24 v5, 3277, v4
    v_lshrrev_b32 v5, 16, v5
    v_mul_u32_u24 v5, 9920, v5
    v_mul_u32_u24 v4, 528, v4
    v_add3_u32 v152, v4, v5, v8
    v_add_u32 v4, 48, v3
    v_mul_u32_u24 v5, 3277, v4
    v_lshrrev_b32 v5, 16, v5
    v_mul_u32_u24 v5, 9920, v5
    v_mul_u32_u24 v4, 528, v4
    v_add3_u32 v153, v4, v5, v8
    v_add_u32 v4, 64, v3
    v_mul_u32_u24 v5, 3277, v4
    v_lshrrev_b32 v5, 16, v5
    v_mul_u32_u24 v5, 9920, v5
    v_mul_u32_u24 v4, 528, v4
    v_add3_u32 v154, v4, v5, v8
    s_setprio 2
    v_mov_b32 v14, 163456
    v_lshrrev_b32 v2, 4, v0
    s_mov_b32 s12, 0x3f803f80
    v_pk_mov_b32 v[4:5], 0, 0
    v_pk_mov_b32 v[6:7], 0, 0
    s_waitcnt vmcnt(0)
    v_dot2_f32_bf16 v4, v164, s12, v4
    v_dot2_f32_bf16 v5, v165, s12, v5
    v_dot2_f32_bf16 v4, v166, s12, v4
    v_dot2_f32_bf16 v5, v167, s12, v5
    v_dot2_f32_bf16 v4, v168, s12, v4
    v_dot2_f32_bf16 v5, v169, s12, v5
    v_dot2_f32_bf16 v4, v170, s12, v4
    v_dot2_f32_bf16 v5, v171, s12, v5
    v_dot2_f32_bf16 v4, v172, s12, v4
    v_dot2_f32_bf16 v5, v173, s12, v5
    v_dot2_f32_bf16 v4, v174, s12, v4
    v_dot2_f32_bf16 v5, v175, s12, v5
    v_dot2_f32_bf16 v4, v176, s12, v4
    v_dot2_f32_bf16 v5, v177, s12, v5
    v_dot2_f32_bf16 v4, v178, s12, v4
    v_dot2_f32_bf16 v5, v179, s12, v5
    v_dot2_f32_bf16 v4, v180, s12, v4
    v_dot2_f32_bf16 v5, v181, s12, v5
    v_dot2_f32_bf16 v4, v182, s12, v4
    v_dot2_f32_bf16 v5, v183, s12, v5
    v_dot2_f32_bf16 v6, v184, s12, v6
    v_dot2_f32_bf16 v7, v185, s12, v7
    v_dot2_f32_bf16 v6, v186, s12, v6
    v_dot2_f32_bf16 v7, v187, s12, v7
    v_dot2_f32_bf16 v6, v188, s12, v6
    v_dot2_f32_bf16 v7, v189, s12, v7
    v_dot2_f32_bf16 v6, v190, s12, v6
    v_dot2_f32_bf16 v7, v191, s12, v7
    v_dot2_f32_bf16 v6, v192, s12, v6
    v_dot2_f32_bf16 v7, v193, s12, v7
    v_dot2_f32_bf16 v6, v194, s12, v6
    v_dot2_f32_bf16 v7, v195, s12, v7
    v_dot2_f32_bf16 v6, v196, s12, v6
    v_dot2_f32_bf16 v7, v197, s12, v7
    v_dot2_f32_bf16 v6, v198, s12, v6
    v_dot2_f32_bf16 v7, v199, s12, v7
    v_dot2_f32_bf16 v6, v200, s12, v6
    v_dot2_f32_bf16 v7, v201, s12, v7
    v_dot2_f32_bf16 v6, v202, s12, v6
    v_dot2_f32_bf16 v7, v203, s12, v7
    v_add_f32 v4, v4, v5
    s_nop 1
    v_add_f32 v6, v6, v7
    v_add_f32_dpp v4, v4, v4 row_ror:8 row_mask:0xf bank_mask:0xf
    s_nop 0
    v_add_f32_dpp v6, v6, v6 row_ror:8 row_mask:0xf bank_mask:0xf
    v_lshlrev_b32 v64, 16, v164
    v_and_b32 v65, 0xffff0000, v164
    v_lshlrev_b32 v66, 16, v165
    v_and_b32 v67, 0xffff0000, v165
    v_lshlrev_b32 v68, 16, v166
    v_and_b32 v69, 0xffff0000, v166
    v_lshlrev_b32 v70, 16, v167
    v_and_b32 v71, 0xffff0000, v167
    v_lshlrev_b32 v72, 16, v168
    v_and_b32 v73, 0xffff0000, v168
    v_add_f32_dpp v4, v4, v4 row_ror:4 row_mask:0xf bank_mask:0xf
    v_add_f32_dpp v6, v6, v6 row_ror:4 row_mask:0xf bank_mask:0xf
    v_lshlrev_b32 v74, 16, v169
    v_and_b32 v75, 0xffff0000, v169
    v_lshlrev_b32 v76, 16, v170
    v_and_b32 v77, 0xffff0000, v170
    v_lshlrev_b32 v78, 16, v171
    v_and_b32 v79, 0xffff0000, v171
    v_lshlrev_b32 v80, 16, v172
    v_and_b32 v81, 0xffff0000, v172
    v_lshlrev_b32 v82, 16, v173
    v_and_b32 v83, 0xffff0000, v173
    v_add_f32_dpp v4, v4, v4 row_ror:2 row_mask:0xf bank_mask:0xf
    v_add_f32_dpp v6, v6, v6 row_ror:2 row_mask:0xf bank_mask:0xf
    v_lshlrev_b32 v84, 16, v174
    v_and_b32 v85, 0xffff0000, v174
    v_lshlrev_b32 v86, 16, v175
    v_and_b32 v87, 0xffff0000, v175
    v_lshlrev_b32 v88, 16, v176
    v_and_b32 v89, 0xffff0000, v176
    v_lshlrev_b32 v90, 16, v177
    v_and_b32 v91, 0xffff0000, v177
    v_lshlrev_b32 v92, 16, v178
    v_and_b32 v93, 0xffff0000, v178
    v_add_f32_dpp v4, v4, v4 row_ror:1 row_mask:0xf bank_mask:0xf
    v_add_f32_dpp v6, v6, v6 row_ror:1 row_mask:0xf bank_mask:0xf
    v_lshlrev_b32 v94, 16, v179
    v_and_b32 v95, 0xffff0000, v179
    v_lshlrev_b32 v96, 16, v180
    v_and_b32 v97, 0xffff0000, v180
    v_lshlrev_b32 v98, 16, v181
    v_and_b32 v99, 0xffff0000, v181
    v_lshlrev_b32 v100, 16, v182
    v_and_b32 v101, 0xffff0000, v182
    v_lshlrev_b32 v102, 16, v183
    v_and_b32 v103, 0xffff0000, v183
    v_mul_f32 v4, 0x3acccccd, v4
    v_mul_f32 v6, 0x3acccccd, v6
    v_cvt_pk_bf16_f32 v5, v4, v6
    v_lshlrev_b32 v8, 16, v5
    v_and_b32 v9, 0xffff0000, v5
    v_sub_f32 v56, 0, v8
    v_sub_f32 v57, 0, v8
    v_sub_f32 v58, 0, v9
    v_sub_f32 v59, 0, v9
    v_pk_mov_b32 v[10:11], 0, 0
    v_pk_mov_b32 v[12:13], 0, 0
    v_lshlrev_b32 v104, 16, v184
    v_and_b32 v105, 0xffff0000, v184
    v_lshlrev_b32 v106, 16, v185
    v_and_b32 v107, 0xffff0000, v185
    v_lshlrev_b32 v108, 16, v186
    v_and_b32 v109, 0xffff0000, v186
    v_lshlrev_b32 v110, 16, v187
    v_and_b32 v111, 0xffff0000, v187
    v_lshlrev_b32 v112, 16, v188
    v_and_b32 v113, 0xffff0000, v188
    v_lshlrev_b32 v114, 16, v189
    v_and_b32 v115, 0xffff0000, v189
    v_lshlrev_b32 v116, 16, v190
    v_and_b32 v117, 0xffff0000, v190
    v_lshlrev_b32 v118, 16, v191
    v_and_b32 v119, 0xffff0000, v191
    v_lshlrev_b32 v120, 16, v192
    v_and_b32 v121, 0xffff0000, v192
    v_lshlrev_b32 v122, 16, v193
    v_and_b32 v123, 0xffff0000, v193
    v_lshlrev_b32 v124, 16, v194
    v_and_b32 v125, 0xffff0000, v194
    v_lshlrev_b32 v126, 16, v195
    v_and_b32 v127, 0xffff0000, v195
    v_lshlrev_b32 v128, 16, v196
    v_and_b32 v129, 0xffff0000, v196
    v_lshlrev_b32 v130, 16, v197
    v_and_b32 v131, 0xffff0000, v197
    v_lshlrev_b32 v132, 16, v198
    v_and_b32 v133, 0xffff0000, v198
    v_lshlrev_b32 v134, 16, v199
    v_and_b32 v135, 0xffff0000, v199
    v_lshlrev_b32 v136, 16, v200
    v_and_b32 v137, 0xffff0000, v200
    v_lshlrev_b32 v138, 16, v201
    v_and_b32 v139, 0xffff0000, v201
    v_lshlrev_b32 v140, 16, v202
    v_and_b32 v141, 0xffff0000, v202
    v_lshlrev_b32 v142, 16, v203
    v_and_b32 v143, 0xffff0000, v203
    v_pk_add_f32 v[64:65], v[64:65], v[56:57]
    v_pk_add_f32 v[66:67], v[66:67], v[56:57]
    v_pk_add_f32 v[68:69], v[68:69], v[56:57]
    v_pk_add_f32 v[70:71], v[70:71], v[56:57]
    v_pk_add_f32 v[72:73], v[72:73], v[56:57]
    v_pk_add_f32 v[74:75], v[74:75], v[56:57]
    v_pk_add_f32 v[76:77], v[76:77], v[56:57]
    v_pk_add_f32 v[78:79], v[78:79], v[56:57]
    v_pk_add_f32 v[80:81], v[80:81], v[56:57]
    v_pk_add_f32 v[82:83], v[82:83], v[56:57]
    v_pk_add_f32 v[84:85], v[84:85], v[56:57]
    v_pk_add_f32 v[86:87], v[86:87], v[56:57]
    v_pk_add_f32 v[88:89], v[88:89], v[56:57]
    v_pk_add_f32 v[90:91], v[90:91], v[56:57]
    v_pk_add_f32 v[92:93], v[92:93], v[56:57]
    v_pk_add_f32 v[94:95], v[94:95], v[56:57]
    v_pk_add_f32 v[96:97], v[96:97], v[56:57]
    v_pk_add_f32 v[98:99], v[98:99], v[56:57]
    v_pk_add_f32 v[100:101], v[100:101], v[56:57]
    v_pk_add_f32 v[102:103], v[102:103], v[56:57]
    v_pk_fma_f32 v[10:11], v[64:65], v[64:65], v[10:11]
    v_pk_fma_f32 v[10:11], v[66:67], v[66:67], v[10:11]
    v_pk_fma_f32 v[10:11], v[68:69], v[68:69], v[10:11]
    v_pk_fma_f32 v[10:11], v[70:71], v[70:71], v[10:11]
    v_pk_fma_f32 v[10:11], v[72:73], v[72:73], v[10:11]
    v_pk_fma_f32 v[10:11], v[74:75], v[74:75], v[10:11]
    v_pk_fma_f32 v[10:11], v[76:77], v[76:77], v[10:11]
    v_pk_fma_f32 v[10:11], v[78:79], v[78:79], v[10:11]
    v_pk_fma_f32 v[10:11], v[80:81], v[80:81], v[10:11]
    v_pk_fma_f32 v[10:11], v[82:83], v[82:83], v[10:11]
    v_pk_fma_f32 v[10:11], v[84:85], v[84:85], v[10:11]
    v_pk_fma_f32 v[10:11], v[86:87], v[86:87], v[10:11]
    v_pk_fma_f32 v[10:11], v[88:89], v[88:89], v[10:11]
    v_pk_fma_f32 v[10:11], v[90:91], v[90:91], v[10:11]
    v_pk_fma_f32 v[10:11], v[92:93], v[92:93], v[10:11]
    v_pk_fma_f32 v[10:11], v[94:95], v[94:95], v[10:11]
    v_pk_fma_f32 v[10:11], v[96:97], v[96:97], v[10:11]
    v_pk_fma_f32 v[10:11], v[98:99], v[98:99], v[10:11]
    v_pk_fma_f32 v[10:11], v[100:101], v[100:101], v[10:11]
    v_pk_fma_f32 v[10:11], v[102:103], v[102:103], v[10:11]
    v_pk_add_f32 v[104:105], v[104:105], v[58:59]
    v_pk_add_f32 v[106:107], v[106:107], v[58:59]
    v_pk_add_f32 v[108:109], v[108:109], v[58:59]
    v_pk_add_f32 v[110:111], v[110:111], v[58:59]
    v_pk_add_f32 v[112:113], v[112:113], v[58:59]
    v_pk_add_f32 v[114:115], v[114:115], v[58:59]
    v_pk_add_f32 v[116:117], v[116:117], v[58:59]
    v_pk_add_f32 v[118:119], v[118:119], v[58:59]
    v_pk_add_f32 v[120:121], v[120:121], v[58:59]
    v_pk_add_f32 v[122:123], v[122:123], v[58:59]
    v_pk_add_f32 v[124:125], v[124:125], v[58:59]
    v_pk_add_f32 v[126:127], v[126:127], v[58:59]
    v_pk_add_f32 v[128:129], v[128:129], v[58:59]
    v_pk_add_f32 v[130:131], v[130:131], v[58:59]
    v_pk_add_f32 v[132:133], v[132:133], v[58:59]
    v_pk_add_f32 v[134:135], v[134:135], v[58:59]
    v_pk_add_f32 v[136:137], v[136:137], v[58:59]
    v_pk_add_f32 v[138:139], v[138:139], v[58:59]
    v_pk_add_f32 v[140:141], v[140:141], v[58:59]
    v_pk_add_f32 v[142:143], v[142:143], v[58:59]
    v_pk_fma_f32 v[12:13], v[104:105], v[104:105], v[12:13]
    v_pk_fma_f32 v[12:13], v[106:107], v[106:107], v[12:13]
    v_pk_fma_f32 v[12:13], v[108:109], v[108:109], v[12:13]
    v_pk_fma_f32 v[12:13], v[110:111], v[110:111], v[12:13]
    v_pk_fma_f32 v[12:13], v[112:113], v[112:113], v[12:13]
    v_pk_fma_f32 v[12:13], v[114:115], v[114:115], v[12:13]
    v_pk_fma_f32 v[12:13], v[116:117], v[116:117], v[12:13]
    v_pk_fma_f32 v[12:13], v[118:119], v[118:119], v[12:13]
    v_pk_fma_f32 v[12:13], v[120:121], v[120:121], v[12:13]
    v_pk_fma_f32 v[12:13], v[122:123], v[122:123], v[12:13]
    v_pk_fma_f32 v[12:13], v[124:125], v[124:125], v[12:13]
    v_pk_fma_f32 v[12:13], v[126:127], v[126:127], v[12:13]
    v_pk_fma_f32 v[12:13], v[128:129], v[128:129], v[12:13]
    v_pk_fma_f32 v[12:13], v[130:131], v[130:131], v[12:13]
    v_pk_fma_f32 v[12:13], v[132:133], v[132:133], v[12:13]
    v_pk_fma_f32 v[12:13], v[134:135], v[134:135], v[12:13]
    v_pk_fma_f32 v[12:13], v[136:137], v[136:137], v[12:13]
    v_pk_fma_f32 v[12:13], v[138:139], v[138:139], v[12:13]
    v_pk_fma_f32 v[12:13], v[140:141], v[140:141], v[12:13]
    v_pk_fma_f32 v[12:13], v[142:143], v[142:143], v[12:13]
    v_add_f32 v10, v10, v11
    v_add_f32 v12, v12, v13
    s_nop 0
    v_add_f32_dpp v10, v10, v10 row_ror:8 row_mask:0xf bank_mask:0xf
    v_add_f32_dpp v12, v12, v12 row_ror:8 row_mask:0xf bank_mask:0xf
    v_cvt_pk_bf16_f32 v164, v64, v65
    v_cvt_pk_bf16_f32 v165, v66, v67
    v_add_f32_dpp v10, v10, v10 row_ror:4 row_mask:0xf bank_mask:0xf
    v_add_f32_dpp v12, v12, v12 row_ror:4 row_mask:0xf bank_mask:0xf
    v_cvt_pk_bf16_f32 v166, v68, v69
    v_cvt_pk_bf16_f32 v167, v70, v71
    v_add_f32_dpp v10, v10, v10 row_ror:2 row_mask:0xf bank_mask:0xf
    v_add_f32_dpp v12, v12, v12 row_ror:2 row_mask:0xf bank_mask:0xf
    v_cvt_pk_bf16_f32 v168, v72, v73
    v_cvt_pk_bf16_f32 v169, v74, v75
    v_add_f32_dpp v10, v10, v10 row_ror:1 row_mask:0xf bank_mask:0xf
    v_add_f32_dpp v12, v12, v12 row_ror:1 row_mask:0xf bank_mask:0xf
    v_cvt_pk_bf16_f32 v170, v76, v77
    v_cvt_pk_bf16_f32 v171, v78, v79
    v_sub_f32 v4, v4, v8
    v_sub_f32 v6, v6, v9
    v_mul_f32 v4, v4, v4
    v_mul_f32 v6, v6, v6
    s_mov_b32 s12, 0x3acccccd
    v_fma_f32 v4, v10, s12, -v4
    v_fma_f32 v6, v12, s12, -v6
    v_max_f32 v4, 0, v4
    v_max_f32 v6, 0, v6
    v_cvt_pk_bf16_f32 v7, v4, v6
    v_lshlrev_b32 v4, 16, v7
    v_and_b32 v6, 0xffff0000, v7
    v_add_f32 v4, 0x3727c5ac, v4
    v_add_f32 v6, 0x3727c5ac, v6
    v_cvt_pk_bf16_f32 v7, v4, v6
    v_lshlrev_b32 v4, 16, v7
    v_and_b32 v6, 0xffff0000, v7
    v_sqrt_f32 v4, v4
    v_sqrt_f32 v6, v6
    s_nop 0
    v_cvt_pk_bf16_f32 v7, v4, v6
    v_lshlrev_b32 v4, 16, v7
    v_and_b32 v6, 0xffff0000, v7
    v_rcp_f32 v60, v4
    v_rcp_f32 v61, v4
    v_rcp_f32 v62, v6
    v_rcp_f32 v63, v6
    v_and_b32 v12, 0xffff, v5
    v_or_b32 v12, v12, v4
    v_lshrrev_b32 v13, 16, v5
    v_or_b32 v13, v13, v6
    s_lshl_b32 s11, s14, 2
    s_add_u32 s11, s11, 10092544
    v_lshlrev_b32 v1, 3, v2
    s_load_dwordx4 s[28:31], s[46:47], 0
    v_cvt_pk_bf16_f32 v172, v80, v81
    v_cvt_pk_bf16_f32 v173, v82, v83
    v_cvt_pk_bf16_f32 v174, v84, v85
    v_cvt_pk_bf16_f32 v175, v86, v87
    v_cvt_pk_bf16_f32 v176, v88, v89
    v_cvt_pk_bf16_f32 v177, v90, v91
    v_cvt_pk_bf16_f32 v178, v92, v93
    v_cvt_pk_bf16_f32 v179, v94, v95
    v_cvt_pk_bf16_f32 v180, v96, v97
    v_cvt_pk_bf16_f32 v181, v98, v99
    v_cvt_pk_bf16_f32 v182, v100, v101
    v_cvt_pk_bf16_f32 v183, v102, v103
    v_cvt_pk_bf16_f32 v184, v104, v105
    v_cvt_pk_bf16_f32 v185, v106, v107
    v_cvt_pk_bf16_f32 v186, v108, v109
    v_cvt_pk_bf16_f32 v187, v110, v111
    v_cvt_pk_bf16_f32 v188, v112, v113
    v_cvt_pk_bf16_f32 v189, v114, v115
    v_cvt_pk_bf16_f32 v190, v116, v117
    v_cvt_pk_bf16_f32 v191, v118, v119
    v_cvt_pk_bf16_f32 v192, v120, v121
    v_cvt_pk_bf16_f32 v193, v122, v123
    v_cvt_pk_bf16_f32 v194, v124, v125
    v_cvt_pk_bf16_f32 v195, v126, v127
    v_cvt_pk_bf16_f32 v196, v128, v129
    v_cvt_pk_bf16_f32 v197, v130, v131
    v_cvt_pk_bf16_f32 v198, v132, v133
    v_cvt_pk_bf16_f32 v199, v134, v135
    v_cvt_pk_bf16_f32 v200, v136, v137
    v_cvt_pk_bf16_f32 v201, v138, v139
    v_cvt_pk_bf16_f32 v202, v140, v141
    v_cvt_pk_bf16_f32 v203, v142, v143
    v_lshlrev_b32 v64, 16, v164
    v_and_b32 v65, 0xffff0000, v164
    v_lshlrev_b32 v66, 16, v165
    v_and_b32 v67, 0xffff0000, v165
    v_lshlrev_b32 v68, 16, v166
    v_and_b32 v69, 0xffff0000, v166
    v_lshlrev_b32 v70, 16, v167
    v_and_b32 v71, 0xffff0000, v167
    v_lshlrev_b32 v72, 16, v168
    v_and_b32 v73, 0xffff0000, v168
    v_lshlrev_b32 v74, 16, v169
    v_and_b32 v75, 0xffff0000, v169
    v_lshlrev_b32 v76, 16, v170
    v_and_b32 v77, 0xffff0000, v170
    v_lshlrev_b32 v78, 16, v171
    v_and_b32 v79, 0xffff0000, v171
    v_lshlrev_b32 v80, 16, v172
    v_and_b32 v81, 0xffff0000, v172
    v_lshlrev_b32 v82, 16, v173
    v_and_b32 v83, 0xffff0000, v173
    v_lshlrev_b32 v84, 16, v174
    v_and_b32 v85, 0xffff0000, v174
    v_lshlrev_b32 v86, 16, v175
    v_and_b32 v87, 0xffff0000, v175
    v_lshlrev_b32 v88, 16, v176
    v_and_b32 v89, 0xffff0000, v176
    v_lshlrev_b32 v90, 16, v177
    v_and_b32 v91, 0xffff0000, v177
    v_lshlrev_b32 v92, 16, v178
    v_and_b32 v93, 0xffff0000, v178
    v_lshlrev_b32 v94, 16, v179
    v_and_b32 v95, 0xffff0000, v179
    v_lshlrev_b32 v96, 16, v180
    v_and_b32 v97, 0xffff0000, v180
    v_lshlrev_b32 v98, 16, v181
    v_and_b32 v99, 0xffff0000, v181
    v_lshlrev_b32 v100, 16, v182
    v_and_b32 v101, 0xffff0000, v182
    v_lshlrev_b32 v102, 16, v183
    v_and_b32 v103, 0xffff0000, v183
    v_lshlrev_b32 v104, 16, v184
    v_and_b32 v105, 0xffff0000, v184
    v_lshlrev_b32 v106, 16, v185
    v_and_b32 v107, 0xffff0000, v185
    v_lshlrev_b32 v108, 16, v186
    v_and_b32 v109, 0xffff0000, v186
    v_lshlrev_b32 v110, 16, v187
    v_and_b32 v111, 0xffff0000, v187
    v_lshlrev_b32 v112, 16, v188
    v_and_b32 v113, 0xffff0000, v188
    v_lshlrev_b32 v114, 16, v189
    v_and_b32 v115, 0xffff0000, v189
    v_lshlrev_b32 v116, 16, v190
    v_and_b32 v117, 0xffff0000, v190
    v_lshlrev_b32 v118, 16, v191
    v_and_b32 v119, 0xffff0000, v191
    v_lshlrev_b32 v120, 16, v192
    v_and_b32 v121, 0xffff0000, v192
    v_lshlrev_b32 v122, 16, v193
    v_and_b32 v123, 0xffff0000, v193
    v_lshlrev_b32 v124, 16, v194
    v_and_b32 v125, 0xffff0000, v194
    v_lshlrev_b32 v126, 16, v195
    v_and_b32 v127, 0xffff0000, v195
    v_lshlrev_b32 v128, 16, v196
    v_and_b32 v129, 0xffff0000, v196
    v_lshlrev_b32 v130, 16, v197
    v_and_b32 v131, 0xffff0000, v197
    v_lshlrev_b32 v132, 16, v198
    v_and_b32 v133, 0xffff0000, v198
    v_lshlrev_b32 v134, 16, v199
    v_and_b32 v135, 0xffff0000, v199
    v_lshlrev_b32 v136, 16, v200
    v_and_b32 v137, 0xffff0000, v200
    v_lshlrev_b32 v138, 16, v201
    v_and_b32 v139, 0xffff0000, v201
    v_lshlrev_b32 v140, 16, v202
    v_and_b32 v141, 0xffff0000, v202
    v_lshlrev_b32 v142, 16, v203
    v_and_b32 v143, 0xffff0000, v203
    v_pk_mul_f32 v[64:65], v[64:65], v[60:61]
    v_pk_mul_f32 v[66:67], v[66:67], v[60:61]
    v_pk_mul_f32 v[68:69], v[68:69], v[60:61]
    v_pk_mul_f32 v[70:71], v[70:71], v[60:61]
    v_pk_mul_f32 v[72:73], v[72:73], v[60:61]
    v_pk_mul_f32 v[74:75], v[74:75], v[60:61]
    v_pk_mul_f32 v[76:77], v[76:77], v[60:61]
    v_pk_mul_f32 v[78:79], v[78:79], v[60:61]
    v_pk_mul_f32 v[80:81], v[80:81], v[60:61]
    v_pk_mul_f32 v[82:83], v[82:83], v[60:61]
    v_pk_mul_f32 v[84:85], v[84:85], v[60:61]
    v_pk_mul_f32 v[86:87], v[86:87], v[60:61]
    v_pk_mul_f32 v[88:89], v[88:89], v[60:61]
    v_pk_mul_f32 v[90:91], v[90:91], v[60:61]
    v_pk_mul_f32 v[92:93], v[92:93], v[60:61]
    v_pk_mul_f32 v[94:95], v[94:95], v[60:61]
    v_pk_mul_f32 v[96:97], v[96:97], v[60:61]
    v_pk_mul_f32 v[98:99], v[98:99], v[60:61]
    v_pk_mul_f32 v[100:101], v[100:101], v[60:61]
    v_pk_mul_f32 v[102:103], v[102:103], v[60:61]
    v_pk_mul_f32 v[104:105], v[104:105], v[62:63]
    v_pk_mul_f32 v[106:107], v[106:107], v[62:63]
    v_pk_mul_f32 v[108:109], v[108:109], v[62:63]
    v_pk_mul_f32 v[110:111], v[110:111], v[62:63]
    v_pk_mul_f32 v[112:113], v[112:113], v[62:63]
    v_pk_mul_f32 v[114:115], v[114:115], v[62:63]
    v_pk_mul_f32 v[116:117], v[116:117], v[62:63]
    v_pk_mul_f32 v[118:119], v[118:119], v[62:63]
    v_pk_mul_f32 v[120:121], v[120:121], v[62:63]
    v_pk_mul_f32 v[122:123], v[122:123], v[62:63]
    v_pk_mul_f32 v[124:125], v[124:125], v[62:63]
    v_pk_mul_f32 v[126:127], v[126:127], v[62:63]
    v_pk_mul_f32 v[128:129], v[128:129], v[62:63]
    v_pk_mul_f32 v[130:131], v[130:131], v[62:63]
    v_pk_mul_f32 v[132:133], v[132:133], v[62:63]
    v_pk_mul_f32 v[134:135], v[134:135], v[62:63]
    v_pk_mul_f32 v[136:137], v[136:137], v[62:63]
    v_pk_mul_f32 v[138:139], v[138:139], v[62:63]
    v_pk_mul_f32 v[140:141], v[140:141], v[62:63]
    v_pk_mul_f32 v[142:143], v[142:143], v[62:63]
    v_cvt_pk_bf16_f32 v64, v64, v104
    v_cvt_pk_bf16_f32 v65, v65, v105
    ds_write2_b32 v150, v64, v65 offset0:0 offset1:16
    v_cvt_pk_bf16_f32 v66, v66, v106
    v_cvt_pk_bf16_f32 v67, v67, v107
    ds_write2_b32 v150, v66, v67 offset0:32 offset1:48
    v_cvt_pk_bf16_f32 v68, v68, v108
    v_cvt_pk_bf16_f32 v69, v69, v109
    ds_write2_b32 v150, v68, v69 offset0:64 offset1:80
    v_cvt_pk_bf16_f32 v70, v70, v110
    v_cvt_pk_bf16_f32 v71, v71, v111
    ds_write2_b32 v150, v70, v71 offset0:96 offset1:112
    v_cvt_pk_bf16_f32 v72, v72, v112
    v_cvt_pk_bf16_f32 v73, v73, v113
    ds_write2_b32 v151, v72, v73 offset0:0 offset1:16
    v_cvt_pk_bf16_f32 v74, v74, v114
    v_cvt_pk_bf16_f32 v75, v75, v115
    ds_write2_b32 v151, v74, v75 offset0:32 offset1:48
    v_cvt_pk_bf16_f32 v76, v76, v116
    v_cvt_pk_bf16_f32 v77, v77, v117
    ds_write2_b32 v151, v76, v77 offset0:64 offset1:80
    v_cvt_pk_bf16_f32 v78, v78, v118
    v_cvt_pk_bf16_f32 v79, v79, v119
    ds_write2_b32 v151, v78, v79 offset0:96 offset1:112
    v_cvt_pk_bf16_f32 v80, v80, v120
    v_cvt_pk_bf16_f32 v81, v81, v121
    ds_write2_b32 v152, v80, v81 offset0:0 offset1:16
    v_cvt_pk_bf16_f32 v82, v82, v122
    v_cvt_pk_bf16_f32 v83, v83, v123
    ds_write2_b32 v152, v82, v83 offset0:32 offset1:48
    v_cvt_pk_bf16_f32 v84, v84, v124
    v_cvt_pk_bf16_f32 v85, v85, v125
    ds_write2_b32 v152, v84, v85 offset0:64 offset1:80
    v_cvt_pk_bf16_f32 v86, v86, v126
    v_cvt_pk_bf16_f32 v87, v87, v127
    ds_write2_b32 v152, v86, v87 offset0:96 offset1:112
    v_cvt_pk_bf16_f32 v88, v88, v128
    v_cvt_pk_bf16_f32 v89, v89, v129
    ds_write2_b32 v153, v88, v89 offset0:0 offset1:16
    v_cvt_pk_bf16_f32 v90, v90, v130
    v_cvt_pk_bf16_f32 v91, v91, v131
    ds_write2_b32 v153, v90, v91 offset0:32 offset1:48
    v_cvt_pk_bf16_f32 v92, v92, v132
    v_cvt_pk_bf16_f32 v93, v93, v133
    ds_write2_b32 v153, v92, v93 offset0:64 offset1:80
    v_cvt_pk_bf16_f32 v94, v94, v134
    v_cvt_pk_bf16_f32 v95, v95, v135
    ds_write2_b32 v153, v94, v95 offset0:96 offset1:112
    v_cvt_pk_bf16_f32 v96, v96, v136
    v_cvt_pk_bf16_f32 v97, v97, v137
    ds_write2_b32 v154, v96, v97 offset0:0 offset1:16
    v_cvt_pk_bf16_f32 v98, v98, v138
    v_cvt_pk_bf16_f32 v99, v99, v139
    ds_write2_b32 v154, v98, v99 offset0:32 offset1:48
    v_cvt_pk_bf16_f32 v100, v100, v140
    v_cvt_pk_bf16_f32 v101, v101, v141
    ds_write2_b32 v154, v100, v101 offset0:64 offset1:80
    v_cvt_pk_bf16_f32 v102, v102, v142
    v_cvt_pk_bf16_f32 v103, v103, v143
    ds_write2_b32 v154, v102, v103 offset0:96 offset1:112
    v_mov_b32 v15, 1
    ds_add_u32 v14, v15
    s_waitcnt lgkmcnt(0)
    s_and_b32 s28, s28, s29
    s_and_b32 s30, s30, s31
    s_and_b32 s28, s28, s30
    s_cbranch_scc1 L_clr_ln
    s_mov_b64 exec, 15
    buffer_load_dword v239, v238, s[64:67], 0 offen sc1
    s_mov_b64 exec, -1
L_poll_17:
    s_waitcnt vmcnt(0)
    v_cmp_ne_u32 vcc, 0, v239
    s_nop 0
    s_and_b32 vcc_lo, vcc_lo, 15
    s_cmp_eq_u32 vcc_lo, 15
    s_cbranch_scc1 L_pdone_18
    s_add_u32 s50, s50, 1
    s_cmp_gt_u32 s50, 100000
    s_cbranch_scc1 L_exit
    s_sleep 8
    s_mov_b64 exec, 15
    buffer_load_dword v239, v238, s[64:67], 0 offen sc1
    s_mov_b64 exec, -1
    s_branch L_poll_17
L_pdone_18:
L_clr_ln:
    s_mov_b32 exec_lo, 0x10001
    s_mov_b32 exec_hi, 0x10001
    buffer_store_dwordx2 v[12:13], v1, s[52:55], s11 offen sc1
    s_mov_b64 exec, -1
    v_lshrrev_b32 v3, 5, v0
    v_lshlrev_b32 v2, 4, v0
    v_lshl_add_u32 v1, v3, 4, v2
    v_add_u32 v1, s69, v1
    s_mul_i32 s10, s9, 40960
    s_mul_i32 s11, s15, 10240
    s_add_u32 s10, s10, s11
    s_mov_b32 s12, 0
L_sbb:
    s_add_u32 s12, s12, 1
    s_cmp_gt_u32 s12, 2000000
    s_cbranch_scc1 L_exit
    ds_read_b32 v15, v14
    s_waitcnt lgkmcnt(0)
    v_readfirstlane_b32 s11, v15
    s_nop 0
    s_cmp_lt_u32 s11, 256
    s_cbranch_scc1 L_sbb
    ds_read_b128 v[164:167], v1 offset:0
    ds_read_b128 v[168:171], v1 offset:1056
    ds_read_b128 v[172:175], v1 offset:2112
    ds_read_b128 v[176:179], v1 offset:3168
    ds_read_b128 v[180:183], v1 offset:4224
    ds_read_b128 v[184:187], v1 offset:5280
    ds_read_b128 v[188:191], v1 offset:6336
    ds_read_b128 v[192:195], v1 offset:7392
    ds_read_b128 v[196:199], v1 offset:8448
    ds_read_b128 v[200:203], v1 offset:9504
    s_waitcnt lgkmcnt(9)
    buffer_store_dwordx4 v[164:167], v2, s[52:55], s10 offen sc1
    s_add_u32 s10, s10, 1024
    s_waitcnt lgkmcnt(8)
    buffer_store_dwordx4 v[168:171], v2, s[52:55], s10 offen sc1
    s_add_u32 s10, s10, 1024
    s_waitcnt lgkmcnt(7)
    buffer_store_dwordx4 v[172:175], v2, s[52:55], s10 offen sc1
    s_add_u32 s10, s10, 1024
    s_waitcnt lgkmcnt(6)
    buffer_store_dwordx4 v[176:179], v2, s[52:55], s10 offen sc1
    s_add_u32 s10, s10, 1024
    s_waitcnt lgkmcnt(5)
    buffer_store_dwordx4 v[180:183], v2, s[52:55], s10 offen sc1
    s_add_u32 s10, s10, 1024
    s_waitcnt lgkmcnt(4)
    buffer_store_dwordx4 v[184:187], v2, s[52:55], s10 offen sc1
    s_add_u32 s10, s10, 1024
    s_waitcnt lgkmcnt(3)
    buffer_store_dwordx4 v[188:191], v2, s[52:55], s10 offen sc1
    s_add_u32 s10, s10, 1024
    s_waitcnt lgkmcnt(2)
    buffer_store_dwordx4 v[192:195], v2, s[52:55], s10 offen sc1
    s_add_u32 s10, s10, 1024
    s_waitcnt lgkmcnt(1)
    buffer_store_dwordx4 v[196:199], v2, s[52:55], s10 offen sc1
    s_add_u32 s10, s10, 1024
    s_waitcnt lgkmcnt(0)
    buffer_store_dwordx4 v[200:203], v2, s[52:55], s10 offen sc1
    s_add_u32 s10, s10, 1024
    s_lshl_b32 s10, s15, 11
    s_add_u32 s10, s10, 10190848
    v_lshlrev_b32 v4, 7, v0
    v_mov_b32 v5, 1
    s_waitcnt vmcnt(0)
    s_mov_b64 exec, 0xffff
    buffer_atomic_add v5, v4, s[52:55], s10 offen sc1
    s_mov_b64 exec, -1
    s_setprio 0
    s_lshl_b32 s8, s9, 2
    s_add_u32 s8, s8, s15
    s_cmp_lg_u32 s8, 255
    s_cbranch_scc1 L_norelay
    v_lshlrev_b32 v6, 6, v0
    s_mov_b32 s8, 10207232
    s_mov_b64 exec, 3
    buffer_load_dword v7, v6, s[64:67], 0 offen offset:128 sc1
    s_mov_b64 exec, -1
L_poll_19:
    s_waitcnt vmcnt(0)
    v_readlane_b32 s9, v7, 0
    v_readlane_b32 s10, v7, 1
    s_nop 0
    s_add_u32 s9, s9, s10
    s_cmp_ge_u32 s9, 64
    s_cbranch_scc1 L_pdone_20
    s_add_u32 s50, s50, 1
    s_cmp_gt_u32 s50, 100000
    s_cbranch_scc1 L_exit
    s_sleep 4
    s_mov_b64 exec, 3
    buffer_load_dword v7, v6, s[64:67], 0 offen offset:128 sc1
    s_mov_b64 exec, -1
    s_branch L_poll_19
L_pdone_20:
    s_mov_b32 exec_hi, 0
    buffer_store_dword v5, v4, s[52:55], s8 offen offset:1024 sc1
    s_mov_b32 exec_hi, -1
L_norelay:
    s_mov_b32 s35, 1
    s_branch L_g2
L_csum:
    s_setprio 3
    s_mov_b32 s12, 0x00003f80
    s_mov_b32 s13, 0x3f800000
    v_and_b32 v3, 3, v0
    v_pk_mov_b32 v[4:5], 0, 0
    v_pk_mov_b32 v[6:7], 0, 0
    v_pk_mov_b32 v[8:9], 0, 0
    v_pk_mov_b32 v[10:11], 0, 0
    s_waitcnt vmcnt(0)
    v_dot2_f32_bf16 v4, v164, s12, v4
    v_dot2_f32_bf16 v5, v164, s13, v5
    v_dot2_f32_bf16 v6, v165, s12, v6
    v_dot2_f32_bf16 v7, v165, s13, v7
    v_dot2_f32_bf16 v8, v166, s12, v8
    v_dot2_f32_bf16 v9, v166, s13, v9
    v_dot2_f32_bf16 v10, v167, s12, v10
    v_dot2_f32_bf16 v11, v167, s13, v11
    v_dot2_f32_bf16 v4, v168, s12, v4
    v_dot2_f32_bf16 v5, v168, s13, v5
    v_dot2_f32_bf16 v6, v169, s12, v6
    v_dot2_f32_bf16 v7, v169, s13, v7
    v_dot2_f32_bf16 v8, v170, s12, v8
    v_dot2_f32_bf16 v9, v170, s13, v9
    v_dot2_f32_bf16 v10, v171, s12, v10
    v_dot2_f32_bf16 v11, v171, s13, v11
    v_dot2_f32_bf16 v4, v172, s12, v4
    v_dot2_f32_bf16 v5, v172, s13, v5
    v_dot2_f32_bf16 v6, v173, s12, v6
    v_dot2_f32_bf16 v7, v173, s13, v7
    v_dot2_f32_bf16 v8, v174, s12, v8
    v_dot2_f32_bf16 v9, v174, s13, v9
    v_dot2_f32_bf16 v10, v175, s12, v10
    v_dot2_f32_bf16 v11, v175, s13, v11
    v_dot2_f32_bf16 v4, v176, s12, v4
    v_dot2_f32_bf16 v5, v176, s13, v5
    v_dot2_f32_bf16 v6, v177, s12, v6
    v_dot2_f32_bf16 v7, v177, s13, v7
    v_dot2_f32_bf16 v8, v178, s12, v8
    v_dot2_f32_bf16 v9, v178, s13, v9
    v_dot2_f32_bf16 v10, v179, s12, v10
    v_dot2_f32_bf16 v11, v179, s13, v11
    v_dot2_f32_bf16 v4, v180, s12, v4
    v_dot2_f32_bf16 v5, v180, s13, v5
    v_dot2_f32_bf16 v6, v181, s12, v6
    v_dot2_f32_bf16 v7, v181, s13, v7
    v_dot2_f32_bf16 v8, v182, s12, v8
    v_dot2_f32_bf16 v9, v182, s13, v9
    v_dot2_f32_bf16 v10, v183, s12, v10
    v_dot2_f32_bf16 v11, v183, s13, v11
    v_dot2_f32_bf16 v4, v184, s12, v4
    v_dot2_f32_bf16 v5, v184, s13, v5
    v_dot2_f32_bf16 v6, v185, s12, v6
    v_dot2_f32_bf16 v7, v185, s13, v7
    v_dot2_f32_bf16 v8, v186, s12, v8
    v_dot2_f32_bf16 v9, v186, s13, v9
    v_dot2_f32_bf16 v10, v187, s12, v10
    v_dot2_f32_bf16 v11, v187, s13, v11
    v_dot2_f32_bf16 v4, v188, s12, v4
    v_dot2_f32_bf16 v5, v188, s13, v5
    v_dot2_f32_bf16 v6, v189, s12, v6
    v_dot2_f32_bf16 v7, v189, s13, v7
    v_dot2_f32_bf16 v8, v190, s12, v8
    v_dot2_f32_bf16 v9, v190, s13, v9
    v_dot2_f32_bf16 v10, v191, s12, v10
    v_dot2_f32_bf16 v11, v191, s13, v11
    v_dot2_f32_bf16 v4, v192, s12, v4
    v_dot2_f32_bf16 v5, v192, s13, v5
    v_dot2_f32_bf16 v6, v193, s12, v6
    v_dot2_f32_bf16 v7, v193, s13, v7
    v_dot2_f32_bf16 v8, v194, s12, v8
    v_dot2_f32_bf16 v9, v194, s13, v9
    v_dot2_f32_bf16 v10, v195, s12, v10
    v_dot2_f32_bf16 v11, v195, s13, v11
    v_dot2_f32_bf16 v4, v196, s12, v4
    v_dot2_f32_bf16 v5, v196, s13, v5
    v_dot2_f32_bf16 v6, v197, s12, v6
    v_dot2_f32_bf16 v7, v197, s13, v7
    v_dot2_f32_bf16 v8, v198, s12, v8
    v_dot2_f32_bf16 v9, v198, s13, v9
    v_dot2_f32_bf16 v10, v199, s12, v10
    v_dot2_f32_bf16 v11, v199, s13, v11
    v_dot2_f32_bf16 v4, v200, s12, v4
    v_dot2_f32_bf16 v5, v200, s13, v5
    v_dot2_f32_bf16 v6, v201, s12, v6
    v_dot2_f32_bf16 v7, v201, s13, v7
    v_dot2_f32_bf16 v8, v202, s12, v8
    v_dot2_f32_bf16 v9, v202, s13, v9
    v_dot2_f32_bf16 v10, v203, s12, v10
    v_dot2_f32_bf16 v11, v203, s13, v11
    v_add_f32_dpp v4, v4, v4 row_ror:8 row_mask:0xf bank_mask:0xf
    v_add_f32_dpp v5, v5, v5 row_ror:8 row_mask:0xf bank_mask:0xf
    v_add_f32_dpp v6, v6, v6 row_ror:8 row_mask:0xf bank_mask:0xf
    v_add_f32_dpp v7, v7, v7 row_ror:8 row_mask:0xf bank_mask:0xf
    v_add_f32_dpp v8, v8, v8 row_ror:8 row_mask:0xf bank_mask:0xf
    v_add_f32_dpp v9, v9, v9 row_ror:8 row_mask:0xf bank_mask:0xf
    v_add_f32_dpp v10, v10, v10 row_ror:8 row_mask:0xf bank_mask:0xf
    v_add_f32_dpp v11, v11, v11 row_ror:8 row_mask:0xf bank_mask:0xf
    v_add_f32_dpp v4, v4, v4 row_ror:4 row_mask:0xf bank_mask:0xf
    v_add_f32_dpp v5, v5, v5 row_ror:4 row_mask:0xf bank_mask:0xf
    v_add_f32_dpp v6, v6, v6 row_ror:4 row_mask:0xf bank_mask:0xf
    v_add_f32_dpp v7, v7, v7 row_ror:4 row_mask:0xf bank_mask:0xf
    v_add_f32_dpp v8, v8, v8 row_ror:4 row_mask:0xf bank_mask:0xf
    v_add_f32_dpp v9, v9, v9 row_ror:4 row_mask:0xf bank_mask:0xf
    v_add_f32_dpp v10, v10, v10 row_ror:4 row_mask:0xf bank_mask:0xf
    v_add_f32_dpp v11, v11, v11 row_ror:4 row_mask:0xf bank_mask:0xf
    v_lshrrev_b32 v12, 4, v0
    v_lshlrev_b32 v12, 7, v12
    v_lshl_add_u32 v12, v3, 5, v12
    v_add_u32 v12, s69, v12
    ds_write_b128 v12, v[4:7]
    ds_write_b128 v12, v[8:11] offset:16
    v_and_b32 v12, 31, v0
    v_lshl_add_u32 v13, v12, 2, s69
    ds_read_b32 v16, v13 offset:0
    ds_read_b32 v17, v13 offset:128
    ds_read_b32 v18, v13 offset:256
    ds_read_b32 v19, v13 offset:384
    s_waitcnt lgkmcnt(0)
    v_add_f32 v16, v16, v17
    v_add_f32 v18, v18, v19
    v_add_f32 v16, v16, v18
    v_cvt_pk_bf16_f32 v4, v16, v16
    v_lshlrev_b32 v5, 16, v4
    v_sub_f32 v5, v16, v5
    v_cvt_pk_bf16_f32 v6, v16, v5
    v_and_b32 v7, 0xffff0000, v6
    v_sub_f32 v7, v5, v7
    v_cvt_pk_bf16_f32 v7, v7, v7
    v_and_b32 v7, 0xffff, v7
    v_or_b32 v7, 1, v7
    s_lshl_b32 s12, s9, 8
    s_mul_i32 s13, s15, 13824
    s_add_u32 s12, s12, s13
    s_add_u32 s12, s12, 10100736
    v_lshlrev_b32 v12, 3, v12
    s_waitcnt lgkmcnt(0)
    s_and_b32 s28, s28, s29
    s_and_b32 s30, s30, s31
    s_and_b32 s28, s28, s30
    s_cbranch_scc1 L_clr_cs
    s_mov_b64 exec, 15
    buffer_load_dword v239, v238, s[64:67], 0 offen sc1
    s_mov_b64 exec, -1
L_poll_21:
    s_waitcnt vmcnt(0)
    v_cmp_ne_u32 vcc, 0, v239
    s_nop 0
    s_and_b32 vcc_lo, vcc_lo, 15
    s_cmp_eq_u32 vcc_lo, 15
    s_cbranch_scc1 L_pdone_22
    s_add_u32 s50, s50, 1
    s_cmp_gt_u32 s50, 100000
    s_cbranch_scc1 L_exit
    s_sleep 8
    s_mov_b64 exec, 15
    buffer_load_dword v239, v238, s[64:67], 0 offen sc1
    s_mov_b64 exec, -1
    s_branch L_poll_21
L_pdone_22:
L_clr_cs:
    v_lshl_or_b32 v7, v145, 16, v7
    s_mov_b32 exec_hi, 0
    buffer_store_dwordx2 v[6:7], v12, s[52:55], s12 offen sc1
    s_mov_b32 exec_hi, -1
    s_setprio 0
    s_mov_b32 s35, 4
    s_branch L_kg_loop
L_w2mid:
    s_setprio 3
    v_lshlrev_b32 v2, 4, v0
    s_waitcnt vmcnt(0)
    ds_write_b128 v247, v[164:167] offset:0
    ds_write_b128 v247, v[168:171] offset:1024
    ds_write_b128 v247, v[172:175] offset:2048
    ds_write_b128 v247, v[176:179] offset:3072
    ds_write_b128 v247, v[180:183] offset:4096
    ds_write_b128 v247, v[184:187] offset:5120
    ds_write_b128 v247, v[188:191] offset:6144
    ds_write_b128 v247, v[192:195] offset:7168
    ds_write_b128 v247, v[196:199] offset:8192
    ds_write_b128 v247, v[200:203] offset:9216
    ds_write_b128 v247, v[148:151] offset:10240
    ds_write_b128 v247, v[152:155] offset:11264
    v_lshrrev_b32 v6, 5, v0
    v_bfe_u32 v7, v0, 4, 1
    v_lshlrev_b32 v6, 4, v6
    v_lshl_add_u32 v6, v7, 2, v6
    v_bfe_u32 v7, v0, 2, 2
    v_add_u32 v6, v6, v7
    v_lshlrev_b32 v6, 7, v6
    v_and_b32 v7, 3, v0
    v_lshl_add_u32 v6, v7, 3, v6
    v_add_u32 v6, s69, v6
    ds_read_b64_tr_b16 v[164:165], v6 offset:0
    ds_read_b64_tr_b16 v[166:167], v6 offset:1024
    ds_read_b64_tr_b16 v[168:169], v6 offset:32
    ds_read_b64_tr_b16 v[170:171], v6 offset:1056
    ds_read_b64_tr_b16 v[172:173], v6 offset:64
    ds_read_b64_tr_b16 v[174:175], v6 offset:1088
    ds_read_b64_tr_b16 v[176:177], v6 offset:96
    ds_read_b64_tr_b16 v[178:179], v6 offset:1120
    s_waitcnt lgkmcnt(6)
    buffer_store_dwordx4 v[164:167], v2, s[52:55], s96 offen sc1
    s_add_u32 s96, s96, 55296
    s_waitcnt lgkmcnt(4)
    buffer_store_dwordx4 v[168:171], v2, s[52:55], s96 offen sc1
    s_add_u32 s96, s96, 55296
    s_waitcnt lgkmcnt(2)
    buffer_store_dwordx4 v[172:175], v2, s[52:55], s96 offen sc1
    s_add_u32 s96, s96, 55296
    s_waitcnt lgkmcnt(0)
    buffer_store_dwordx4 v[176:179], v2, s[52:55], s96 offen sc1
    s_add_u32 s96, s96, 55296
    ds_read_b64_tr_b16 v[180:181], v6 offset:4096
    ds_read_b64_tr_b16 v[182:183], v6 offset:5120
    ds_read_b64_tr_b16 v[184:185], v6 offset:4128
    ds_read_b64_tr_b16 v[186:187], v6 offset:5152
    ds_read_b64_tr_b16 v[188:189], v6 offset:4160
    ds_read_b64_tr_b16 v[190:191], v6 offset:5184
    ds_read_b64_tr_b16 v[192:193], v6 offset:4192
    ds_read_b64_tr_b16 v[194:195], v6 offset:5216
    s_waitcnt lgkmcnt(6)
    buffer_store_dwordx4 v[180:183], v2, s[52:55], s97 offen sc1
    s_add_u32 s97, s97, 55296
    s_waitcnt lgkmcnt(4)
    buffer_store_dwordx4 v[184:187], v2, s[52:55], s97 offen sc1
    s_add_u32 s97, s97, 55296
    s_waitcnt lgkmcnt(2)
    buffer_store_dwordx4 v[188:191], v2, s[52:55], s97 offen sc1
    s_add_u32 s97, s97, 55296
    s_waitcnt lgkmcnt(0)
    buffer_store_dwordx4 v[192:195], v2, s[52:55], s97 offen sc1
    s_add_u32 s97, s97, 55296
    ds_read_b64_tr_b16 v[196:197], v6 offset:8192
    ds_read_b64_tr_b16 v[198:199], v6 offset:9216
    ds_read_b64_tr_b16 v[200:201], v6 offset:8224
    ds_read_b64_tr_b16 v[202:203], v6 offset:9248
    ds_read_b64_tr_b16 v[148:149], v6 offset:8256
    ds_read_b64_tr_b16 v[150:151], v6 offset:9280
    ds_read_b64_tr_b16 v[152:153], v6 offset:8288
    ds_read_b64_tr_b16 v[154:155], v6 offset:9312
    s_waitcnt lgkmcnt(6)
    buffer_store_dwordx4 v[196:199], v2, s[52:55], s98 offen sc1
    s_add_u32 s98, s98, 55296
    s_waitcnt lgkmcnt(4)
    buffer_store_dwordx4 v[200:203], v2, s[52:55], s98 offen sc1
    s_add_u32 s98, s98, 55296
    s_waitcnt lgkmcnt(2)
    buffer_store_dwordx4 v[148:151], v2, s[52:55], s98 offen sc1
    s_add_u32 s98, s98, 55296
    s_waitcnt lgkmcnt(0)
    buffer_store_dwordx4 v[152:155], v2, s[52:55], s98 offen sc1
    s_add_u32 s98, s98, 55296
    s_setprio 2
    s_mov_b32 s35, 6
    s_branch L_kg_loop
L_w2sig:
    v_mov_b32 v4, 163460
    v_mov_b32 v5, 1
    v_mov_b32 v6, 0
    s_waitcnt vmcnt(0)
    s_mov_b64 exec, 1
    ds_add_rtn_u32 v7, v4, v5
    s_waitcnt lgkmcnt(0)
    v_readfirstlane_b32 s10, v7
    s_and_b32 s11, s9, 1
    s_lshl_b32 s11, s11, 6
    s_add_u32 s11, s11, 128
    s_cmp_eq_u32 s10, 3
    s_cselect_b32 s11, s11, 0x7f000000
    buffer_atomic_add v5, v6, s[64:67], s11 offen sc1
    s_mov_b64 exec, -1
    s_setprio 1
    s_mov_b32 s35, 0
    s_branch L_kg_nsig
L_kg_done:
    s_waitcnt vmcnt(4)
    s_cmp_ge_u32 s35, 3
    s_cbranch_scc1 L_clr_fin
    s_load_dwordx4 s[28:31], s[46:47], 0
    s_waitcnt lgkmcnt(0)
    s_and_b32 s28, s28, s29
    s_and_b32 s30, s30, s31
    s_and_b32 s28, s28, s30
    s_cbranch_scc1 L_clr_fin
    s_mov_b64 exec, 15
    buffer_load_dword v239, v238, s[64:67], 0 offen sc1
    s_mov_b64 exec, -1
L_poll_23:
    s_waitcnt vmcnt(0)
    v_cmp_ne_u32 vcc, 0, v239
    s_nop 0
    s_and_b32 vcc_lo, vcc_lo, 15
    s_cmp_eq_u32 vcc_lo, 15
    s_cbranch_scc1 L_pdone_24
    s_add_u32 s50, s50, 1
    s_cmp_gt_u32 s50, 100000
    s_cbranch_scc1 L_exit
    s_sleep 8
    s_mov_b64 exec, 15
    buffer_load_dword v239, v238, s[64:67], 0 offen sc1
    s_mov_b64 exec, -1
    s_branch L_poll_23
L_pdone_24:
L_clr_fin:
    s_waitcnt lgkmcnt(0)
    s_cmp_lt_u32 s4, 4
    s_cbranch_scc1 L_kg_nc
    s_cmp_eq_u32 s68, 2
    s_cbranch_scc1 L_kg_nc
    s_waitcnt vmcnt(0)
    s_load_dword s33, s[48:49], s100 glc
L_kg_nc:
    s_nop 7
    s_setprio 2
    v_lshlrev_b32 v1, 4, v0
    v_add_u32 v13, s69, v1
    v_pk_mov_b32 v[4:5], 0, 0
    v_pk_mov_b32 v[6:7], 0, 0
    ds_write_b128 v13, v[4:7] offset:512
    ds_write_b128 v13, v[4:7] offset:1536
    ds_write_b128 v13, v[4:7] offset:2560
    v_and_b32 v3, 31, v0
    v_lshlrev_b32 v2, 4, v3
    v_sub_u32 v2, s69, v2
    v_add_u32 v2, 512, v2
    v_cvt_pk_bf16_f32 v16, v215, v214
    v_cvt_pk_bf16_f32 v17, v213, v212
    v_cvt_pk_bf16_f32 v18, v211, v210
    v_cvt_pk_bf16_f32 v19, v209, v208
    v_cvt_pk_bf16_f32 v20, v212, v211
    v_cvt_pk_bf16_f32 v21, v210, v210
    v_cvt_pk_bf16_f32 v22, v210, v209
    v_cvt_pk_bf16_f32 v23, v208, v208
    v_cvt_pk_bf16_f32 v24, 0, 0
    v_cvt_pk_bf16_f32 v25, v217, v217
    v_cvt_pk_bf16_f32 v26, v217, v216
    v_cvt_pk_bf16_f32 v27, v216, v216
    v_cvt_pk_bf16_f32 v28, v217, v218
    v_cvt_pk_bf16_f32 v29, v221, v222
    v_cvt_pk_bf16_f32 v30, v217, v219
    v_cvt_pk_bf16_f32 v31, v221, v223
    v_and_b32 v8, 1, v3
    v_and_b32 v10, 30, v3
    v_mul_u32_u24 v9, 320, v8
    v_mul_u32_u24 v8, 640, v8
    s_add_u32 s10, s69, 1648
    v_sub_u32 v10, s10, v10
    v_add_u32 v8, v8, v10
    v_add_u32 v9, v9, v10
    s_mov_b32 exec_hi, 0
    ds_write_b128 v2, v[16:19] offset:1072
    ds_write_b16 v9, v30 offset:1406
    ds_write_b16 v9, v30 offset:1564
    ds_write_b16_d16_hi v9, v30 offset:1374
    ds_write_b16_d16_hi v9, v30 offset:1532
    ds_write_b16 v9, v31 offset:1342
    ds_write_b16 v9, v31 offset:1500
    ds_write_b16_d16_hi v9, v31 offset:1310
    ds_write_b16_d16_hi v9, v31 offset:1468
    s_mov_b32 exec_hi, -1
    s_mov_b32 exec_lo, 0
    ds_write_b128 v2, v[20:23] offset:560
    ds_write_b16 v8, v28 offset:94
    ds_write_b16 v8, v28 offset:252
    ds_write_b16_d16_hi v8, v28 offset:414
    ds_write_b16_d16_hi v8, v28 offset:572
    ds_write_b16 v8, v29 offset:62
    ds_write_b16 v8, v29 offset:220
    ds_write_b16_d16_hi v8, v29 offset:382
    ds_write_b16_d16_hi v8, v29 offset:540
    s_mov_b32 exec_hi, 1
    ds_write_b128 v2, v[24:27] offset:48
    ds_write_b16 v8, v4 offset:94
    ds_write_b16 v8, v4 offset:252
    s_mov_b64 exec, -1
    s_cmp_lt_u32 s4, 4
    s_cbranch_scc1 L_kexp
    s_cmp_eq_u32 s68, 2
    s_cbranch_scc1 L_cv_kpart
    s_waitcnt lgkmcnt(0)
    s_cmp_ge_u32 s33, 64
    s_cbranch_scc0 L_cv_kpart
    s_lshl_b32 s10, s51, 6
    buffer_load_dwordx4 v[148:151], v146, s[52:55], s10 offen sc1
    s_add_u32 s10, s10, 655360
    buffer_load_dwordx4 v[152:155], v146, s[52:55], s10 offen sc1
    s_add_u32 s10, s10, 655360
    buffer_load_dwordx4 v[156:159], v146, s[52:55], s10 offen sc1
    s_add_u32 s10, s10, 655360
    buffer_load_dwordx4 v[160:163], v146, s[52:55], s10 offen sc1
    s_add_u32 s10, s10, 655360
    s_mov_b32 s68, 2
L_cv_kpart:
    v_mov_b32 v5, s69
    ds_read_u16 v34, v5 offset:2640
    ds_read_b128 v[16:19], v247 offset:512
    ds_read_b64 v[20:21], v247 offset:528
    ds_read_b128 v[24:27], v248 offset:1536
    ds_read_b64 v[28:29], v248 offset:1552
    ds_read2_b32 v[164:165], v249 offset0:0 offset1:1
    ds_read2_b32 v[166:167], v249 offset0:2 offset1:3
    ds_read2_b32 v[168:169], v249 offset0:4 offset1:5
    ds_read2_b32 v[170:171], v249 offset0:6 offset1:7
    ds_read2_b32 v[172:173], v249 offset0:8 offset1:9
    ds_read2_b32 v[174:175], v249 offset0:10 offset1:11
    ds_read2_b32 v[176:177], v249 offset0:12 offset1:13
    ds_read2_b32 v[178:179], v249 offset0:14 offset1:15
    ds_read2_b32 v[180:181], v249 offset0:16 offset1:17
    ds_read2_b32 v[182:183], v249 offset0:18 offset1:19
    ds_read2_b32 v[184:185], v249 offset0:20 offset1:21
    ds_read2_b32 v[186:187], v249 offset0:22 offset1:23
    ds_read2_b32 v[188:189], v250 offset0:24 offset1:25
    ds_read2_b32 v[190:191], v250 offset0:26 offset1:27
    ds_read2_b32 v[192:193], v250 offset0:16 offset1:17
    ds_read2_b32 v[194:195], v250 offset0:18 offset1:19
    ds_read2_b32 v[196:197], v250 offset0:8 offset1:9
    ds_read2_b32 v[198:199], v250 offset0:10 offset1:11
    ds_read2_b32 v[200:201], v250 offset0:0 offset1:1
    ds_read2_b32 v[202:203], v250 offset0:2 offset1:3
    v_lshl_or_b32 v5, v147, 16, v147
    v_and_b32 v204, v204, v5
    v_and_b32 v205, v205, v5
    v_and_b32 v206, v206, v5
    v_and_b32 v207, v207, v5
    s_waitcnt lgkmcnt(15)
    v_lshl_or_b32 v5, v34, 16, v34
    v_and_b32 v224, v224, v5
    v_and_b32 v225, v225, v5
    v_and_b32 v226, v226, v5
    v_and_b32 v227, v227, v5
    v_mov_b32 v64, v16
    v_mov_b32 v65, v17
    v_alignbit_b32 v66, v17, v16, 16
    v_alignbit_b32 v67, v18, v17, 16
    ds_write_b128 v254, v[64:67] offset:0
    v_mov_b32 v68, v17
    v_mov_b32 v69, v18
    v_alignbit_b32 v70, v18, v17, 16
    v_alignbit_b32 v71, v19, v18, 16
    ds_write_b128 v254, v[68:71] offset:16
    v_mov_b32 v72, v18
    v_mov_b32 v73, v19
    v_alignbit_b32 v74, v19, v18, 16
    v_alignbit_b32 v75, v20, v19, 16
    ds_write_b128 v254, v[72:75] offset:32
    v_mov_b32 v76, v19
    v_mov_b32 v77, v20
    v_alignbit_b32 v78, v20, v19, 16
    v_alignbit_b32 v79, v21, v20, 16
    ds_write_b128 v254, v[76:79] offset:48
    v_mov_b32 v80, v24
    v_mov_b32 v81, v25
    v_alignbit_b32 v82, v25, v24, 16
    v_alignbit_b32 v83, v26, v25, 16
    ds_write_b128 v255, v[80:83] offset:4608
    v_mov_b32 v84, v25
    v_mov_b32 v85, v26
    v_alignbit_b32 v86, v26, v25, 16
    v_alignbit_b32 v87, v27, v26, 16
    ds_write_b128 v255, v[84:87] offset:4624
    v_mov_b32 v88, v26
    v_mov_b32 v89, v27
    v_alignbit_b32 v90, v27, v26, 16
    v_alignbit_b32 v91, v28, v27, 16
    ds_write_b128 v255, v[88:91] offset:4640
    v_mov_b32 v92, v27
    v_mov_b32 v93, v28
    v_alignbit_b32 v94, v28, v27, 16
    v_alignbit_b32 v95, v29, v28, 16
    ds_write_b128 v255, v[92:95] offset:4656
    ds_read_b64 v[232:233], v231
    ds_read_b64 v[234:235], v236
    s_cmp_lg_u32 s101, 0
    s_cbranch_scc1 L_cv_direct
L_cv_upart:
    s_setprio 2
    v_pk_mov_b32 v[4:5], 0, 0
    v_pk_mov_b32 v[6:7], 0, 0
    s_mov_b64 exec, 0x3fffffff
    ds_write_b128 v247, v[4:7] offset:5056
    s_mov_b64 exec, 3
    ds_write_b128 v247, v[4:7] offset:9616
    ds_write_b128 v247, v[4:7] offset:12720
    ds_write_b128 v247, v[4:7] offset:15824
    ds_write_b128 v247, v[4:7] offset:17904
    ds_write_b128 v247, v[4:7] offset:19984
    s_mov_b64 exec, -1
    s_bitcmp1_b32 s68, 1
    s_cbranch_scc1 L_cv_u2
    s_load_dword s33, s[48:49], s100 glc
L_spoll_25:
    s_waitcnt lgkmcnt(0)
    s_cmp_ge_u32 s33, 64
    s_cbranch_scc1 L_sdone_26
    s_add_u32 s50, s50, 1
    s_cmp_gt_u32 s50, 100000
    s_cbranch_scc1 L_exit
    s_sleep 6
    s_load_dword s33, s[48:49], s100 glc
    s_branch L_spoll_25
L_sdone_26:
    s_lshl_b32 s10, s51, 6
    buffer_load_dwordx4 v[148:151], v146, s[52:55], s10 offen sc1
    s_add_u32 s10, s10, 655360
    buffer_load_dwordx4 v[152:155], v146, s[52:55], s10 offen sc1
    s_add_u32 s10, s10, 655360
    buffer_load_dwordx4 v[156:159], v146, s[52:55], s10 offen sc1
    s_add_u32 s10, s10, 655360
    buffer_load_dwordx4 v[160:163], v146, s[52:55], s10 offen sc1
    s_add_u32 s10, s10, 655360
L_cv_u2:
    s_mov_b32 s31, 0
    s_bitcmp1_b32 s68, 0
    s_cbranch_scc1 L_cv_u3
    s_cmp_eq_u32 s101, 0
    s_cbranch_scc1 L_cv_u3
    s_load_dword s31, s[48:49], s34 glc
L_cv_u3:
    s_waitcnt vmcnt(0)
    ds_write_b128 v247, v[148:151] offset:5536
    ds_write_b128 v247, v[152:155] offset:6560
    ds_write_b128 v247, v[156:159] offset:7584
    ds_write_b128 v247, v[160:163] offset:8608
    v_mov_b32 v13, v247
    s_mov_b32 s3, 0
    ds_read_b64 v[128:129], v13 offset:5512
    ds_read_b128 v[130:133], v13 offset:5520
    ds_read_b64 v[134:135], v13 offset:5536
    s_waitcnt lgkmcnt(0)
    s_and_b32 s13, s31, s101
    s_cbranch_scc0 L_cv_win
    s_lshl_b32 s10, s51, 12
    s_add_u32 s10, s10, 2621440
    buffer_load_dwordx4 v[32:35], v1, s[52:55], s10 offen offset:0 sc1
    buffer_load_dwordx4 v[36:39], v1, s[52:55], s10 offen offset:1024 sc1
    buffer_load_dwordx4 v[40:43], v1, s[52:55], s10 offen offset:2048 sc1
    s_or_b32 s68, s68, 1
L_cv_win:
    v_lshlrev_b32 v96, 16, v128
    v_and_b32 v97, 0xffff0000, v128
    v_lshlrev_b32 v98, 16, v129
    v_and_b32 v99, 0xffff0000, v129
    v_lshlrev_b32 v100, 16, v130
    v_and_b32 v101, 0xffff0000, v130
    v_lshlrev_b32 v102, 16, v131
    v_and_b32 v103, 0xffff0000, v131
    v_lshlrev_b32 v104, 16, v132
    v_and_b32 v105, 0xffff0000, v132
    v_lshlrev_b32 v106, 16, v133
    v_and_b32 v107, 0xffff0000, v133
    v_lshlrev_b32 v108, 16, v134
    v_and_b32 v109, 0xffff0000, v134
    v_lshlrev_b32 v110, 16, v135
    v_and_b32 v111, 0xffff0000, v135
    ds_read_b64 v[128:129], v13 offset:6536
    ds_read_b128 v[130:133], v13 offset:6544
    ds_read_b64 v[134:135], v13 offset:6560
    v_add_f32 v97, v97, v96
    v_add_f32 v98, v98, v97
    v_add_f32 v99, v99, v98
    v_add_f32 v100, v100, v99
    v_add_f32 v101, v101, v100
    v_add_f32 v102, v102, v101
    v_add_f32 v103, v103, v102
    v_add_f32 v104, v104, v103
    v_add_f32 v105, v105, v104
    v_add_f32 v106, v106, v105
    v_add_f32 v107, v107, v106
    v_add_f32 v108, v108, v107
    v_add_f32 v109, v109, v108
    v_add_f32 v110, v110, v109
    v_add_f32 v111, v111, v110
    v_sub_f32 v112, v101, v98
    v_sub_f32 v113, v102, v99
    v_sub_f32 v114, v103, v100
    v_sub_f32 v115, v104, v101
    v_sub_f32 v116, v105, v102
    v_sub_f32 v117, v106, v103
    v_sub_f32 v118, v107, v104
    v_sub_f32 v119, v108, v105
    v_cvt_pk_bf16_f32 v124, v112, v113
    v_cvt_pk_bf16_f32 v125, v114, v115
    v_cvt_pk_bf16_f32 v126, v116, v117
    v_cvt_pk_bf16_f32 v127, v118, v119
    ds_write_b128 v13, v[124:127] offset:9648
    v_sub_f32 v112, v102, v97
    v_sub_f32 v113, v103, v98
    v_sub_f32 v114, v104, v99
    v_sub_f32 v115, v105, v100
    v_sub_f32 v116, v106, v101
    v_sub_f32 v117, v107, v102
    v_sub_f32 v118, v108, v103
    v_sub_f32 v119, v109, v104
    v_cvt_pk_bf16_f32 v120, v112, v113
    v_cvt_pk_bf16_f32 v121, v114, v115
    v_cvt_pk_bf16_f32 v122, v116, v117
    v_cvt_pk_bf16_f32 v123, v118, v119
    ds_write_b128 v13, v[120:123] offset:12752
    s_cmp_eq_u32 s3, 2
    s_cbranch_scc1 L_cv_wend
    v_sub_f32 v112, v103, v96
    v_sub_f32 v113, v104, v97
    v_sub_f32 v114, v105, v98
    v_sub_f32 v115, v106, v99
    v_sub_f32 v116, v107, v100
    v_sub_f32 v117, v108, v101
    v_sub_f32 v118, v109, v102
    v_sub_f32 v119, v110, v103
    v_cvt_pk_bf16_f32 v124, v112, v113
    v_cvt_pk_bf16_f32 v125, v114, v115
    v_cvt_pk_bf16_f32 v126, v116, v117
    v_cvt_pk_bf16_f32 v127, v118, v119
    ds_write_b128 v13, v[124:127] offset:15856
    v_mov_b32 v112, v104
    v_sub_f32 v113, v105, v96
    v_sub_f32 v114, v106, v97
    v_sub_f32 v115, v107, v98
    v_sub_f32 v116, v108, v99
    v_sub_f32 v117, v109, v100
    v_sub_f32 v118, v110, v101
    v_sub_f32 v119, v111, v102
    v_cvt_pk_bf16_f32 v120, v112, v113
    v_cvt_pk_bf16_f32 v121, v114, v115
    v_cvt_pk_bf16_f32 v122, v116, v117
    v_cvt_pk_bf16_f32 v123, v118, v119
    ds_write_b128 v13, v[120:123] offset:17936
    v_add_u32 v13, 1024, v13
    s_add_u32 s3, s3, 1
    s_waitcnt lgkmcnt(4)
    s_branch L_cv_win
L_cv_wend:
    s_cmp_lg_u32 s101, 0
    s_cbranch_scc1 L_cv_rk
L_cv_direct:
    v_add_u32 v8, 2304, v231
    v_add_u32 v9, 2304, v236
    v_mov_b32 v10, v237
    ds_read_b64 v[16:17], v8 offset:2304
    ds_read_b64 v[18:19], v9 offset:2304
    ds_read_b64 v[20:21], v8 offset:0
    ds_read_b64 v[22:23], v9 offset:0
    ds_read_b128 v[24:27], v10 offset:0
    ds_read_b128 v[28:31], v10 offset:512
    ds_read_b128 v[32:35], v10 offset:1024
    ds_read_b128 v[36:39], v10 offset:1536
    ds_read_b128 v[40:43], v10 offset:2048
    ds_read_b128 v[44:47], v10 offset:2560
    ds_read_b128 v[48:51], v10 offset:3072
    ds_read_b128 v[52:55], v10 offset:3584
    v_subrev_u32 v8, 288, v8
    v_subrev_u32 v9, 288, v9
    v_subrev_u32 v10, 64, v10
    s_setprio 2
    s_mov_b32 s3, 0
    s_waitcnt lgkmcnt(0)
    v_mfma_f32_16x16x32_bf16 v[96:99], v[204:207], v[24:27], 0
    v_mfma_f32_16x16x32_bf16 v[100:103], v[204:207], v[28:31], 0
    v_mfma_f32_16x16x32_bf16 v[104:107], v[204:207], v[32:35], 0
    v_mfma_f32_16x16x32_bf16 v[108:111], v[204:207], v[36:39], 0
    v_mfma_f32_16x16x32_bf16 v[112:115], v[204:207], v[40:43], 0
    v_mfma_f32_16x16x32_bf16 v[116:119], v[204:207], v[44:47], 0
    v_mfma_f32_16x16x32_bf16 v[120:123], v[204:207], v[48:51], 0
    v_mfma_f32_16x16x32_bf16 v[124:127], v[204:207], v[52:55], 0
    v_mfma_f32_16x16x32_bf16 v[104:107], v[232:235], v[24:27], v[104:107]
    v_mfma_f32_16x16x32_bf16 v[108:111], v[232:235], v[28:31], v[108:111]
    v_mfma_f32_16x16x32_bf16 v[112:115], v[232:235], v[32:35], v[112:115]
    v_mfma_f32_16x16x32_bf16 v[116:119], v[232:235], v[36:39], v[116:119]
    v_mfma_f32_16x16x32_bf16 v[120:123], v[232:235], v[40:43], v[120:123]
    v_mfma_f32_16x16x32_bf16 v[124:127], v[232:235], v[44:47], v[124:127]
    v_mfma_f32_16x16x32_bf16 v[112:115], v[224:227], v[24:27], v[112:115]
    v_mfma_f32_16x16x32_bf16 v[116:119], v[224:227], v[28:31], v[116:119]
    v_mfma_f32_16x16x32_bf16 v[120:123], v[224:227], v[32:35], v[120:123]
    v_mfma_f32_16x16x32_bf16 v[124:127], v[224:227], v[36:39], v[124:127]
L_cv_loop:
    v_mfma_f32_16x16x32_bf16 v[96:99], v[16:19], v[24:27], v[96:99]
    ds_read_b64 v[56:57], v8 offset:2304
    ds_read_b64 v[58:59], v9 offset:2304
    v_mfma_f32_16x16x32_bf16 v[100:103], v[16:19], v[28:31], v[100:103]
    ds_read_b64 v[60:61], v8 offset:0
    ds_read_b64 v[62:63], v9 offset:0
    v_mfma_f32_16x16x32_bf16 v[104:107], v[16:19], v[32:35], v[104:107]
    ds_read_b128 v[64:67], v10 offset:0
    ds_read_b128 v[68:71], v10 offset:512
    v_mfma_f32_16x16x32_bf16 v[108:111], v[16:19], v[36:39], v[108:111]
    ds_read_b128 v[72:75], v10 offset:1024
    ds_read_b128 v[76:79], v10 offset:1536
    v_mfma_f32_16x16x32_bf16 v[112:115], v[16:19], v[40:43], v[112:115]
    ds_read_b128 v[80:83], v10 offset:2048
    ds_read_b128 v[84:87], v10 offset:2560
    v_mfma_f32_16x16x32_bf16 v[116:119], v[16:19], v[44:47], v[116:119]
    ds_read_b128 v[88:91], v10 offset:3072
    ds_read_b128 v[92:95], v10 offset:3584
    v_mfma_f32_16x16x32_bf16 v[120:123], v[16:19], v[48:51], v[120:123]
    v_subrev_u32 v8, 288, v8
    v_mfma_f32_16x16x32_bf16 v[124:127], v[16:19], v[52:55], v[124:127]
    v_subrev_u32 v9, 288, v9
    v_mfma_f32_16x16x32_bf16 v[100:103], v[20:23], v[24:27], v[100:103]
    v_subrev_u32 v10, 64, v10
    v_mfma_f32_16x16x32_bf16 v[104:107], v[20:23], v[28:31], v[104:107]
    v_mfma_f32_16x16x32_bf16 v[108:111], v[20:23], v[32:35], v[108:111]
    v_mfma_f32_16x16x32_bf16 v[112:115], v[20:23], v[36:39], v[112:115]
    v_mfma_f32_16x16x32_bf16 v[116:119], v[20:23], v[40:43], v[116:119]
    v_mfma_f32_16x16x32_bf16 v[120:123], v[20:23], v[44:47], v[120:123]
    v_mfma_f32_16x16x32_bf16 v[124:127], v[20:23], v[48:51], v[124:127]
    s_waitcnt lgkmcnt(0)
    v_mfma_f32_16x16x32_bf16 v[96:99], v[56:59], v[64:67], v[96:99]
    ds_read_b64 v[16:17], v8 offset:2304
    ds_read_b64 v[18:19], v9 offset:2304
    v_mfma_f32_16x16x32_bf16 v[100:103], v[56:59], v[68:71], v[100:103]
    ds_read_b64 v[20:21], v8 offset:0
    ds_read_b64 v[22:23], v9 offset:0
    v_mfma_f32_16x16x32_bf16 v[104:107], v[56:59], v[72:75], v[104:107]
    ds_read_b128 v[24:27], v10 offset:0
    ds_read_b128 v[28:31], v10 offset:512
    v_mfma_f32_16x16x32_bf16 v[108:111], v[56:59], v[76:79], v[108:111]
    ds_read_b128 v[32:35], v10 offset:1024
    ds_read_b128 v[36:39], v10 offset:1536
    v_mfma_f32_16x16x32_bf16 v[112:115], v[56:59], v[80:83], v[112:115]
    ds_read_b128 v[40:43], v10 offset:2048
    ds_read_b128 v[44:47], v10 offset:2560
    v_mfma_f32_16x16x32_bf16 v[116:119], v[56:59], v[84:87], v[116:119]
    ds_read_b128 v[48:51], v10 offset:3072
    ds_read_b128 v[52:55], v10 offset:3584
    v_mfma_f32_16x16x32_bf16 v[120:123], v[56:59], v[88:91], v[120:123]
    v_subrev_u32 v8, 288, v8
    v_mfma_f32_16x16x32_bf16 v[124:127], v[56:59], v[92:95], v[124:127]
    v_subrev_u32 v9, 288, v9
    v_mfma_f32_16x16x32_bf16 v[100:103], v[60:63], v[64:67], v[100:103]
    v_subrev_u32 v10, 64, v10
    v_mfma_f32_16x16x32_bf16 v[104:107], v[60:63], v[68:71], v[104:107]
    v_mfma_f32_16x16x32_bf16 v[108:111], v[60:63], v[72:75], v[108:111]
    v_mfma_f32_16x16x32_bf16 v[112:115], v[60:63], v[76:79], v[112:115]
    v_mfma_f32_16x16x32_bf16 v[116:119], v[60:63], v[80:83], v[116:119]
    s_add_u32 s3, s3, 1
    s_cmp_lt_u32 s3, 4
    v_mfma_f32_16x16x32_bf16 v[120:123], v[60:63], v[84:87], v[120:123]
    v_mfma_f32_16x16x32_bf16 v[124:127], v[60:63], v[88:91], v[124:127]
    s_waitcnt lgkmcnt(0)
    s_cbranch_scc1 L_cv_loop
L_cv_far:
    ds_read_b64_tr_b16 v[16:17], v251 offset:0
    ds_read_b64_tr_b16 v[18:19], v251 offset:128
    ds_read_b64_tr_b16 v[20:21], v251 offset:256
    ds_read_b64_tr_b16 v[22:23], v251 offset:384
    ds_read_b64_tr_b16 v[24:25], v251 offset:512
    ds_read_b64_tr_b16 v[26:27], v251 offset:640
    ds_read_b64_tr_b16 v[28:29], v251 offset:768
    ds_read_b64_tr_b16 v[30:31], v251 offset:896
    ds_read_b64_tr_b16 v[32:33], v251 offset:1024
    ds_read_b64_tr_b16 v[34:35], v251 offset:1152
    ds_read_b64_tr_b16 v[36:37], v251 offset:1280
    ds_read_b64_tr_b16 v[38:39], v251 offset:1408
    ds_read_b64_tr_b16 v[40:41], v251 offset:1536
    ds_read_b64_tr_b16 v[42:43], v251 offset:1664
    s_waitcnt lgkmcnt(8)
    ds_read_b64_tr_b16 v[44:45], v251 offset:1792
    ds_read_b64_tr_b16 v[46:47], v251 offset:1920
    ds_read_b64_tr_b16 v[48:49], v251 offset:2048
    ds_read_b64_tr_b16 v[50:51], v251 offset:2176
    ds_read_b64_tr_b16 v[52:53], v251 offset:2304
    ds_read_b64_tr_b16 v[54:55], v251 offset:2432
    ds_read_b64_tr_b16 v[56:57], v251 offset:2560
    ds_read_b64_tr_b16 v[58:59], v251 offset:2688
    ds_read_b64_tr_b16 v[60:61], v251 offset:2816
    ds_read_b64_tr_b16 v[62:63], v251 offset:2944
    ds_read_b64_tr_b16 v[64:65], v252 offset:0
    ds_read_b64_tr_b16 v[66:67], v252 offset:128
    ds_read_b64_tr_b16 v[68:69], v252 offset:512
    ds_read_b64_tr_b16 v[70:71], v252 offset:640
    ds_read_b64_tr_b16 v[72:73], v252 offset:1024
    ds_read_b64_tr_b16 v[74:75], v252 offset:1152
    ds_read_b64_tr_b16 v[76:77], v252 offset:1536
    ds_read_b64_tr_b16 v[78:79], v252 offset:1664
    s_waitcnt lgkmcnt(8)
    v_mfma_f32_16x16x32_bf16 v[104:107], v[16:19], v[180:183], v[104:107]
    v_mfma_f32_16x16x32_bf16 v[108:111], v[16:19], v[172:175], v[108:111]
    v_mfma_f32_16x16x32_bf16 v[112:115], v[16:19], v[164:167], v[112:115]
    v_mfma_f32_16x16x32_bf16 v[104:107], v[20:23], v[184:187], v[104:107]
    v_mfma_f32_16x16x32_bf16 v[108:111], v[20:23], v[176:179], v[108:111]
    v_mfma_f32_16x16x32_bf16 v[112:115], v[20:23], v[168:171], v[112:115]
    v_mfma_f32_16x16x32_bf16 v[108:111], v[24:27], v[180:183], v[108:111]
    v_mfma_f32_16x16x32_bf16 v[112:115], v[24:27], v[172:175], v[112:115]
    v_mfma_f32_16x16x32_bf16 v[116:119], v[24:27], v[164:167], v[116:119]
    v_mfma_f32_16x16x32_bf16 v[108:111], v[28:31], v[184:187], v[108:111]
    v_mfma_f32_16x16x32_bf16 v[112:115], v[28:31], v[176:179], v[112:115]
    v_mfma_f32_16x16x32_bf16 v[116:119], v[28:31], v[168:171], v[116:119]
    v_mfma_f32_16x16x32_bf16 v[112:115], v[32:35], v[180:183], v[112:115]
    v_mfma_f32_16x16x32_bf16 v[116:119], v[32:35], v[172:175], v[116:119]
    v_mfma_f32_16x16x32_bf16 v[120:123], v[32:35], v[164:167], v[120:123]
    v_mfma_f32_16x16x32_bf16 v[112:115], v[36:39], v[184:187], v[112:115]
    v_mfma_f32_16x16x32_bf16 v[116:119], v[36:39], v[176:179], v[116:119]
    v_mfma_f32_16x16x32_bf16 v[120:123], v[36:39], v[168:171], v[120:123]
    v_mfma_f32_16x16x32_bf16 v[116:119], v[40:43], v[180:183], v[116:119]
    v_mfma_f32_16x16x32_bf16 v[120:123], v[40:43], v[172:175], v[120:123]
    v_mfma_f32_16x16x32_bf16 v[124:127], v[40:43], v[164:167], v[124:127]
    v_mfma_f32_16x16x32_bf16 v[116:119], v[44:47], v[184:187], v[116:119]
    v_mfma_f32_16x16x32_bf16 v[120:123], v[44:47], v[176:179], v[120:123]
    v_mfma_f32_16x16x32_bf16 v[124:127], v[44:47], v[168:171], v[124:127]
    v_mfma_f32_16x16x32_bf16 v[120:123], v[48:51], v[180:183], v[120:123]
    v_mfma_f32_16x16x32_bf16 v[124:127], v[48:51], v[172:175], v[124:127]
    v_mfma_f32_16x16x32_bf16 v[120:123], v[52:55], v[184:187], v[120:123]
    v_mfma_f32_16x16x32_bf16 v[124:127], v[52:55], v[176:179], v[124:127]
    v_mfma_f32_16x16x32_bf16 v[124:127], v[56:59], v[180:183], v[124:127]
    v_mfma_f32_16x16x32_bf16 v[124:127], v[60:63], v[184:187], v[124:127]
    s_waitcnt lgkmcnt(0)
    v_mfma_f32_16x16x32_bf16 v[112:115], v[64:67], v[188:191], v[112:115]
    v_mfma_f32_16x16x32_bf16 v[116:119], v[64:67], v[192:195], v[116:119]
    v_mfma_f32_16x16x32_bf16 v[120:123], v[64:67], v[196:199], v[120:123]
    v_mfma_f32_16x16x32_bf16 v[124:127], v[64:67], v[200:203], v[124:127]
    v_mfma_f32_16x16x32_bf16 v[116:119], v[68:71], v[188:191], v[116:119]
    v_mfma_f32_16x16x32_bf16 v[120:123], v[68:71], v[192:195], v[120:123]
    v_mfma_f32_16x16x32_bf16 v[124:127], v[68:71], v[196:199], v[124:127]
    v_mfma_f32_16x16x32_bf16 v[120:123], v[72:75], v[188:191], v[120:123]
    v_mfma_f32_16x16x32_bf16 v[124:127], v[72:75], v[192:195], v[124:127]
    v_mfma_f32_16x16x32_bf16 v[124:127], v[76:79], v[188:191], v[124:127]
    s_lshl_b32 s14, s51, 7
    s_add_u32 s14, s14, 5242880
    s_nop 7
    v_cvt_pk_bf16_f32 v16, v96, v97
    v_cvt_pk_bf16_f32 v17, v98, v99
    v_cvt_pk_bf16_f32 v18, v100, v101
    v_cvt_pk_bf16_f32 v19, v102, v103
    s_nop 0
    v_permlane16_swap_b32 v16, v18
    v_permlane16_swap_b32 v17, v19
    buffer_store_dwordx4 v[16:19], v253, s[52:55], s14 offen sc1
    s_add_u32 s14, s14, 655360
    v_cvt_pk_bf16_f32 v20, v104, v105
    v_cvt_pk_bf16_f32 v21, v106, v107
    v_cvt_pk_bf16_f32 v22, v108, v109
    v_cvt_pk_bf16_f32 v23, v110, v111
    s_nop 0
    v_permlane16_swap_b32 v20, v22
    v_permlane16_swap_b32 v21, v23
    buffer_store_dwordx4 v[20:23], v253, s[52:55], s14 offen sc1
    s_add_u32 s14, s14, 655360
    v_cvt_pk_bf16_f32 v24, v112, v113
    v_cvt_pk_bf16_f32 v25, v114, v115
    v_cvt_pk_bf16_f32 v26, v116, v117
    v_cvt_pk_bf16_f32 v27, v118, v119
    s_nop 0
    v_permlane16_swap_b32 v24, v26
    v_permlane16_swap_b32 v25, v27
    buffer_store_dwordx4 v[24:27], v253, s[52:55], s14 offen sc1
    s_add_u32 s14, s14, 655360
    v_cvt_pk_bf16_f32 v28, v120, v121
    v_cvt_pk_bf16_f32 v29, v122, v123
    v_cvt_pk_bf16_f32 v30, v124, v125
    v_cvt_pk_bf16_f32 v31, v126, v127
    s_nop 0
    v_permlane16_swap_b32 v28, v30
    v_permlane16_swap_b32 v29, v31
    buffer_store_dwordx4 v[28:31], v253, s[52:55], s14 offen sc1
    s_add_u32 s14, s14, 655360
    s_mul_i32 s13, s51, 820
    s_lshr_b32 s13, s13, 16
    s_lshl_b32 s14, s13, 9
    s_add_u32 s14, s14, 10199040
    v_lshlrev_b32 v4, 7, v0
    v_mov_b32 v5, 1
    s_waitcnt vmcnt(0)
    s_mov_b64 exec, 15
    buffer_atomic_add v5, v4, s[52:55], s14 offen sc1
    s_mov_b64 exec, -1
    s_setprio 0
    s_cmp_eq_u32 s4, 7
    s_cbranch_scc1 L_fetch
    s_branch L_end
L_kexp:
    ds_read_b128 v[16:19], v13 offset:512
    ds_read_b128 v[20:23], v13 offset:1536
    ds_read_b128 v[24:27], v13 offset:2560
    s_lshl_b32 s9, s51, 12
    s_add_u32 s9, s9, 2621440
    s_waitcnt lgkmcnt(2)
    buffer_store_dwordx4 v[16:19], v1, s[52:55], s9 offen offset:0 sc1
    s_waitcnt lgkmcnt(1)
    buffer_store_dwordx4 v[20:23], v1, s[52:55], s9 offen offset:1024 sc1
    s_waitcnt lgkmcnt(0)
    buffer_store_dwordx4 v[24:27], v1, s[52:55], s9 offen offset:2048 sc1
    s_sub_u32 s8, s51, 256
    s_lshr_b32 s8, s8, 3
    s_lshl_b32 s8, s8, 2
    s_add_u32 s8, s8, s4
    s_cmp_ge_u32 s8, 144
    s_cselect_b32 s12, 1, 0
    s_mul_i32 s9, s12, 144
    s_sub_u32 s8, s8, s9
    s_mul_i32 s9, s8, 1821
    s_lshr_b32 s9, s9, 16
    s_mul_i32 s10, s9, 36
    s_sub_u32 s8, s8, s10
    s_cmp_ge_u32 s8, 20
    s_cselect_b32 s10, 1, 0
    s_mul_i32 s11, s10, 20
    s_sub_u32 s8, s8, s11
    s_lshl_b32 s8, s8, 3
    s_lshl_b32 s9, s9, 1
    s_add_u32 s8, s8, s9
    s_add_u32 s8, s8, s10
    s_lshl_b32 s8, s8, 7
    s_add_u32 s8, s8, 10158080
    s_lshl_b32 s9, 0x1000000, s12
    v_mov_b32 v4, 0
    v_mov_b32 v5, s9
    s_waitcnt vmcnt(0)
    s_mov_b64 exec, 1
    buffer_atomic_or v5, v4, s[52:55], s8 offen sc1
    s_mov_b64 exec, -1
    s_setprio 0
    s_mov_b32 s35, 1
    s_branch L_g2
L_cv_rk:
    s_bitcmp1_b32 s68, 0
    s_cbranch_scc1 L_cv_k1
    s_load_dword s31, s[48:49], s34 glc
L_spoll_27:
    s_waitcnt lgkmcnt(0)
    s_and_b32 s13, s31, s101
    s_cbranch_scc1 L_sdone_28
    s_add_u32 s50, s50, 1
    s_cmp_gt_u32 s50, 100000
    s_cbranch_scc1 L_exit
    s_sleep 6
    s_load_dword s31, s[48:49], s34 glc
    s_branch L_spoll_27
L_sdone_28:
    s_lshl_b32 s10, s51, 12
    s_add_u32 s10, s10, 2621440
    buffer_load_dwordx4 v[32:35], v1, s[52:55], s10 offen offset:0 sc1
    buffer_load_dwordx4 v[36:39], v1, s[52:55], s10 offen offset:1024 sc1
    buffer_load_dwordx4 v[40:43], v1, s[52:55], s10 offen offset:2048 sc1
L_cv_k1:
    s_waitcnt vmcnt(2)
    ds_write_b128 v247, v[32:35] offset:512
    s_waitcnt vmcnt(1)
    ds_write_b128 v247, v[36:39] offset:1536
    s_waitcnt vmcnt(0)
    ds_write_b128 v247, v[40:43] offset:2560
    s_branch L_cv_kpart
L_end:
L_exit:
    s_endpgm
.section .rodata,"a"
.p2align 6
.amdhsa_kernel parallel_sum__ssm_conv_s4__dense_activation_gelu__prompt_kernel
  .amdhsa_next_free_vgpr 256
  .amdhsa_next_free_sgpr 102
  .amdhsa_accum_offset 256
  .amdhsa_group_segment_fixed_size 0
  .amdhsa_kernarg_size 136
  .amdhsa_user_sgpr_count 2
  .amdhsa_user_sgpr_kernarg_segment_ptr 1
  .amdhsa_system_sgpr_workgroup_id_x 1
.end_amdhsa_kernel
```
